```python
import torch

def _softmax(x, axis=-1):
    return torch.softmax(x, dim=axis)
def _gelu(x):
    return torch.nn.functional.gelu(x, approximate="tanh")
def _silu(x):
    return torch.nn.functional.silu(x)
def _sigmoid(x):
    return torch.sigmoid(x)
def _layernorm(x, axis=-1, eps=1e-5):
    m = x.mean(dim=axis, keepdim=True)
    v = x.var(dim=axis, keepdim=True, unbiased=False)
    return (x - m) / torch.sqrt(v + eps)
def _scatter_add(tgt, idx, src, axis=0):
    return tgt.clone().index_add_(axis, idx, src)
def _segment_sum(src, seg, n):
    out = torch.zeros((n,) + src.shape[1:], dtype=src.dtype)
    return out.index_add_(0, seg, src)
def _pad(x, pw):
    flat = tuple(v for pair in reversed(pw) for v in pair)
    return torch.nn.functional.pad(x, flat)

kernel_name = 'parallel_sum__spectral_gfnet__mixer_channel_mlp__prompt'

def setup_inputs():

    _w = (lambda a: (lambda t: t.to(torch.bfloat16) if t.is_floating_point() else t)(torch.as_tensor(a)))
    def _A_setup():
        B, S, D = 1, 2048, 640
        Df = D // 2 + 1
        return {
            "x": _w((lambda *s: torch.randn(*s, dtype=torch.bfloat16) * 0.05)(B, S, D)),
            "w_r": _w((lambda *s: torch.randn(*s, dtype=torch.bfloat16) * 0.8)(S, Df) * 0.02),
            "w_i": _w((lambda *s: torch.randn(*s, dtype=torch.bfloat16) * 0.8)(S, Df) * 0.02),
        }
    _A_in = _A_setup()

    def _B_setup():
        B, S, D, F = 1, 2048, 640, 1728
        return {
            "x": _w((lambda *s: torch.randn(*s, dtype=torch.bfloat16) * 0.05)(B, S, D)),
            "w1": _w((lambda *s: torch.randn(*s, dtype=torch.bfloat16) * 0.8)(D, F) * (D ** -0.5)),
            "b1": _w((lambda *s: torch.randn(*s, dtype=torch.bfloat16) * 0.4)(F)),
            "w2": _w((lambda *s: torch.randn(*s, dtype=torch.bfloat16) * 0.05)(F, D) * (F ** -0.5)),
            "b2": _w((lambda *s: torch.randn(*s, dtype=torch.bfloat16) * 0.05)(D)),
        }
    _B_in = _B_setup()

    return {
        "A_x": _A_in["x"],
        "A_w_r": _A_in["w_r"],
        "A_w_i": _A_in["w_i"],
        "B_x": _B_in["x"],
        "B_w1": _B_in["w1"],
        "B_b1": _B_in["b1"],
        "B_w2": _B_in["w2"],
        "B_b2": _B_in["b2"],
    }

def reference(A_x, A_w_r, A_w_i, B_x, B_w1, B_b1, B_w2, B_b2):
    def _A_ref(x, w_r, w_i):
        B, S, D = x.shape
        X = (lambda x, axes=(-2,-1): torch.fft.rfft2(x.float(), dim=axes))(x, axes=(-2, -1))
        W = w_r + 1j * w_i
        X = X * W
        y = (lambda x, s, axes=(-2,-1): torch.fft.irfft2(x, s=s, dim=axes).to(torch.bfloat16))(X, (S, D), axes=(-2, -1))
        return y

    def _B_ref(x, w1, b1, w2, b2):
        y = _layernorm(x, axis=-1)
        h = _gelu(torch.einsum("bsd,df->bsf", y, w1) + b1)
        return torch.einsum("bsf,fd->bsd", h, w2) + b2

    x = A_x
    xn = _layernorm(x, axis=-1)
    return x + _A_ref(xn, A_w_r, A_w_i) + _B_ref(xn, B_w1, B_b1, B_w2, B_b2)
```

```asm
; @launch kernel=k1_kernel grid=(448,1,1) block=(256,1,1) lds=40960
; @launch kernel=k2_kernel grid=(252,1,1) block=(256,1,1) lds=163840
; @launch kernel=k3_kernel grid=(256,1,1) block=(256,1,1) lds=90112
.amdgcn_target "amdgcn-amd-amdhsa--gfx950"
.text
.globl k1_kernel
.p2align 8
.type k1_kernel,@function
k1_kernel:
    s_cmp_ge_u32 s2, 448
    s_cbranch_scc1 K1_END
    s_load_dwordx4 s[4:7], s[0:1], 0
    s_load_dwordx2 s[8:9], s[0:1], 16
    s_load_dwordx2 s[10:11], s[0:1], 80
    v_lshrrev_b32 v1, 6, v0
    v_and_b32 v2, 63, v0
    v_readfirstlane_b32 s3, v1
    s_getpc_b64 s[46:47]
CPF1:
    s_add_u32 s46, s46, k1_kernel-CPF1
    s_addc_u32 s47, s47, (k1_kernel-CPF1)>>32
    v_lshlrev_b32 v232, 6, v0
    v_add_u32 v232, 0, v232
    v_min_u32 v232, K1_END-k1_kernel-4, v232
    v_mov_b32 v233, s47
    v_add_co_u32 v232, vcc, s46, v232
    v_addc_co_u32 v233, vcc, 0, v233, vcc
    global_load_dword v20, v[232:233], off
    s_cmp_ge_u32 s2, 256
    s_cbranch_scc1 K1_TR
    s_and_b32 s12, s2, 7
    s_lshl_b32 s12, s12, 3
    s_lshr_b32 s13, s2, 3
    s_and_b32 s15, s13, 7
    s_add_u32 s12, s12, s15
    s_lshr_b32 s13, s13, 3
    v_lshrrev_b32 v3, 3, v0
    v_and_b32 v4, 7, v0
    v_lshlrev_b32 v5, 6, v3
    v_add_u32 v5, s12, v5
    v_mul_u32_u24 v5, 1280, v5
    v_lshl_add_u32 v5, v4, 4, v5
    s_load_dwordx2 s[32:33], s[0:1], 32
    s_waitcnt lgkmcnt(0)
    s_mov_b32 s16, s4
    s_mov_b32 s17, s5
    s_mov_b32 s18, 0x280000
    s_mov_b32 s19, 0x00020000
    s_mov_b32 s20, s10
    s_mov_b32 s21, s11
    s_mov_b32 s22, 0x282000
    s_mov_b32 s23, 0x00020000
    s_add_u32 s24, s10, 0x600000
    s_addc_u32 s25, s11, 0
    s_mov_b32 s26, 0x280000
    s_mov_b32 s27, 0x00020000
    buffer_load_dwordx4 v[20:23], v5, s[16:19], 0 offen offset:0
    buffer_load_dwordx4 v[28:31], v5, s[16:19], 0 offen offset:128
    buffer_load_dwordx4 v[36:39], v5, s[16:19], 0 offen offset:256
    buffer_load_dwordx4 v[44:47], v5, s[16:19], 0 offen offset:384
    buffer_load_dwordx4 v[52:55], v5, s[16:19], 0 offen offset:512
    buffer_load_dwordx4 v[60:63], v5, s[16:19], 0 offen offset:640
    buffer_load_dwordx4 v[68:71], v5, s[16:19], 0 offen offset:768
    buffer_load_dwordx4 v[76:79], v5, s[16:19], 0 offen offset:896
    buffer_load_dwordx4 v[84:87], v5, s[16:19], 0 offen offset:1024
    buffer_load_dwordx4 v[92:95], v5, s[16:19], 0 offen offset:1152
    s_lshr_b32 s14, s13, 1
    s_and_b32 s31, s13, 1
    s_mul_i32 s31, s31, 5
    v_lshrrev_b32 v11, 5, v2
    s_add_u32 s15, s31, s3
    s_lshl_b32 s15, s15, 5
    v_and_b32 v6, 31, v2
    v_add_u32 v6, s15, v6
    v_and_b32 v7, 1, v6
    v_and_b32 v8, 0xfffffffe, v6
    v_add_u32 v8, s14, v8
    v_lshl_add_u32 v9, v8, 1, v7
    v_cmp_eq_u32 vcc, 1, v9
    v_mov_b32 v10, 320
    s_lshl_b32 s15, s12, 6
    v_cndmask_b32 v8, v8, v10, vcc
    v_cndmask_b32 v7, v7, 0, vcc
    v_lshl_add_u32 v9, v8, 1, v7
    v_lshlrev_b32 v9, 12, v9
    v_lshl_add_u32 v9, v11, 5, v9
    v_add_u32 v9, s15, v9
    v_cvt_f32_u32 v8, v8
    v_cvt_f32_u32 v7, v7
    v_lshlrev_b32 v10, 3, v11
    v_cvt_f32_u32 v10, v10
    v_mul_f32 v8, 0x3acccccd, v8
    v_mul_f32 v7, 0x3e800000, v7
    v_fmac_f32 v7, v10, v8
    v_mul_f32 v208, 0x41800000, v8
    v_fmamk_f32 v176, v8, 0x00000000, v7
    v_fmamk_f32 v177, v8, 0x3f800000, v7
    v_fmamk_f32 v178, v8, 0x40000000, v7
    v_fmamk_f32 v179, v8, 0x40400000, v7
    v_fmamk_f32 v180, v8, 0x40800000, v7
    v_fmamk_f32 v181, v8, 0x40a00000, v7
    v_fmamk_f32 v182, v8, 0x40c00000, v7
    v_fmamk_f32 v183, v8, 0x40e00000, v7
    v_fmamk_f32 v184, v8, 0x41800000, v7
    v_fmamk_f32 v185, v8, 0x41880000, v7
    v_fmamk_f32 v186, v8, 0x41900000, v7
    v_fmamk_f32 v187, v8, 0x41980000, v7
    v_fmamk_f32 v188, v8, 0x41a00000, v7
    v_fmamk_f32 v189, v8, 0x41a80000, v7
    v_fmamk_f32 v190, v8, 0x41b00000, v7
    v_fmamk_f32 v191, v8, 0x41b80000, v7
    v_cos_f32 v208, v208
    v_cos_f32 v176, v176
    v_cos_f32 v177, v177
    v_cos_f32 v178, v178
    v_cos_f32 v179, v179
    v_cos_f32 v180, v180
    v_cos_f32 v181, v181
    v_cos_f32 v182, v182
    v_cos_f32 v183, v183
    v_cos_f32 v184, v184
    v_cos_f32 v185, v185
    v_cos_f32 v186, v186
    v_cos_f32 v187, v187
    v_cos_f32 v188, v188
    v_cos_f32 v189, v189
    v_cos_f32 v190, v190
    v_cos_f32 v191, v191
    v_add_f32 v208, v208, v208
    v_cvt_pk_bf16_f32 v96, v176, v177
    v_cvt_pk_bf16_f32 v97, v178, v179
    v_cvt_pk_bf16_f32 v98, v180, v181
    v_cvt_pk_bf16_f32 v99, v182, v183
    v_cvt_pk_bf16_f32 v100, v184, v185
    v_cvt_pk_bf16_f32 v101, v186, v187
    v_cvt_pk_bf16_f32 v102, v188, v189
    v_cvt_pk_bf16_f32 v103, v190, v191
    v_fma_f32 v192, v208, v184, -v176
    v_fma_f32 v193, v208, v185, -v177
    v_fma_f32 v194, v208, v186, -v178
    v_fma_f32 v195, v208, v187, -v179
    v_fma_f32 v196, v208, v188, -v180
    v_fma_f32 v197, v208, v189, -v181
    v_fma_f32 v198, v208, v190, -v182
    v_fma_f32 v199, v208, v191, -v183
    v_cvt_pk_bf16_f32 v104, v192, v193
    v_cvt_pk_bf16_f32 v105, v194, v195
    v_cvt_pk_bf16_f32 v106, v196, v197
    v_cvt_pk_bf16_f32 v107, v198, v199
    v_fma_f32 v176, v208, v192, -v184
    v_fma_f32 v177, v208, v193, -v185
    v_fma_f32 v178, v208, v194, -v186
    v_fma_f32 v179, v208, v195, -v187
    v_fma_f32 v180, v208, v196, -v188
    v_fma_f32 v181, v208, v197, -v189
    v_fma_f32 v182, v208, v198, -v190
    v_fma_f32 v183, v208, v199, -v191
    v_cvt_pk_bf16_f32 v108, v176, v177
    v_cvt_pk_bf16_f32 v109, v178, v179
    v_cvt_pk_bf16_f32 v110, v180, v181
    v_cvt_pk_bf16_f32 v111, v182, v183
    v_fma_f32 v184, v208, v176, -v192
    v_fma_f32 v185, v208, v177, -v193
    v_fma_f32 v186, v208, v178, -v194
    v_fma_f32 v187, v208, v179, -v195
    v_fma_f32 v188, v208, v180, -v196
    v_fma_f32 v189, v208, v181, -v197
    v_fma_f32 v190, v208, v182, -v198
    v_fma_f32 v191, v208, v183, -v199
    v_cvt_pk_bf16_f32 v112, v184, v185
    v_cvt_pk_bf16_f32 v113, v186, v187
    v_cvt_pk_bf16_f32 v114, v188, v189
    v_cvt_pk_bf16_f32 v115, v190, v191
    v_fma_f32 v192, v208, v184, -v176
    v_fma_f32 v193, v208, v185, -v177
    v_fma_f32 v194, v208, v186, -v178
    v_fma_f32 v195, v208, v187, -v179
    v_fma_f32 v196, v208, v188, -v180
    v_fma_f32 v197, v208, v189, -v181
    v_fma_f32 v198, v208, v190, -v182
    v_fma_f32 v199, v208, v191, -v183
    v_cvt_pk_bf16_f32 v116, v192, v193
    v_cvt_pk_bf16_f32 v117, v194, v195
    v_cvt_pk_bf16_f32 v118, v196, v197
    v_cvt_pk_bf16_f32 v119, v198, v199
    v_fma_f32 v176, v208, v192, -v184
    v_fma_f32 v177, v208, v193, -v185
    v_fma_f32 v178, v208, v194, -v186
    v_fma_f32 v179, v208, v195, -v187
    v_fma_f32 v180, v208, v196, -v188
    v_fma_f32 v181, v208, v197, -v189
    v_fma_f32 v182, v208, v198, -v190
    v_fma_f32 v183, v208, v199, -v191
    v_cvt_pk_bf16_f32 v120, v176, v177
    v_cvt_pk_bf16_f32 v121, v178, v179
    v_cvt_pk_bf16_f32 v122, v180, v181
    v_cvt_pk_bf16_f32 v123, v182, v183
    v_fma_f32 v184, v208, v176, -v192
    v_fma_f32 v185, v208, v177, -v193
    v_fma_f32 v186, v208, v178, -v194
    v_fma_f32 v187, v208, v179, -v195
    v_fma_f32 v188, v208, v180, -v196
    v_fma_f32 v189, v208, v181, -v197
    v_fma_f32 v190, v208, v182, -v198
    v_fma_f32 v191, v208, v183, -v199
    v_cvt_pk_bf16_f32 v124, v184, v185
    v_cvt_pk_bf16_f32 v125, v186, v187
    v_cvt_pk_bf16_f32 v126, v188, v189
    v_cvt_pk_bf16_f32 v127, v190, v191
    v_fma_f32 v192, v208, v184, -v176
    v_fma_f32 v193, v208, v185, -v177
    v_fma_f32 v194, v208, v186, -v178
    v_fma_f32 v195, v208, v187, -v179
    v_fma_f32 v196, v208, v188, -v180
    v_fma_f32 v197, v208, v189, -v181
    v_fma_f32 v198, v208, v190, -v182
    v_fma_f32 v199, v208, v191, -v183
    v_cvt_pk_bf16_f32 v128, v192, v193
    v_cvt_pk_bf16_f32 v129, v194, v195
    v_cvt_pk_bf16_f32 v130, v196, v197
    v_cvt_pk_bf16_f32 v131, v198, v199
    v_fma_f32 v176, v208, v192, -v184
    v_fma_f32 v177, v208, v193, -v185
    v_fma_f32 v178, v208, v194, -v186
    v_fma_f32 v179, v208, v195, -v187
    v_fma_f32 v180, v208, v196, -v188
    v_fma_f32 v181, v208, v197, -v189
    v_fma_f32 v182, v208, v198, -v190
    v_fma_f32 v183, v208, v199, -v191
    v_cvt_pk_bf16_f32 v132, v176, v177
    v_cvt_pk_bf16_f32 v133, v178, v179
    v_cvt_pk_bf16_f32 v134, v180, v181
    v_cvt_pk_bf16_f32 v135, v182, v183
    v_fma_f32 v184, v208, v176, -v192
    v_fma_f32 v185, v208, v177, -v193
    v_fma_f32 v186, v208, v178, -v194
    v_fma_f32 v187, v208, v179, -v195
    v_fma_f32 v188, v208, v180, -v196
    v_fma_f32 v189, v208, v181, -v197
    v_fma_f32 v190, v208, v182, -v198
    v_fma_f32 v191, v208, v183, -v199
    v_cvt_pk_bf16_f32 v136, v184, v185
    v_cvt_pk_bf16_f32 v137, v186, v187
    v_cvt_pk_bf16_f32 v138, v188, v189
    v_cvt_pk_bf16_f32 v139, v190, v191
    v_fma_f32 v192, v208, v184, -v176
    v_fma_f32 v193, v208, v185, -v177
    v_fma_f32 v194, v208, v186, -v178
    v_fma_f32 v195, v208, v187, -v179
    v_fma_f32 v196, v208, v188, -v180
    v_fma_f32 v197, v208, v189, -v181
    v_fma_f32 v198, v208, v190, -v182
    v_fma_f32 v199, v208, v191, -v183
    v_cvt_pk_bf16_f32 v140, v192, v193
    v_cvt_pk_bf16_f32 v141, v194, v195
    v_cvt_pk_bf16_f32 v142, v196, v197
    v_cvt_pk_bf16_f32 v143, v198, v199
    v_fma_f32 v176, v208, v192, -v184
    v_fma_f32 v177, v208, v193, -v185
    v_fma_f32 v178, v208, v194, -v186
    v_fma_f32 v179, v208, v195, -v187
    v_fma_f32 v180, v208, v196, -v188
    v_fma_f32 v181, v208, v197, -v189
    v_fma_f32 v182, v208, v198, -v190
    v_fma_f32 v183, v208, v199, -v191
    v_cvt_pk_bf16_f32 v144, v176, v177
    v_cvt_pk_bf16_f32 v145, v178, v179
    v_cvt_pk_bf16_f32 v146, v180, v181
    v_cvt_pk_bf16_f32 v147, v182, v183
    v_fma_f32 v184, v208, v176, -v192
    v_fma_f32 v185, v208, v177, -v193
    v_fma_f32 v186, v208, v178, -v194
    v_fma_f32 v187, v208, v179, -v195
    v_fma_f32 v188, v208, v180, -v196
    v_fma_f32 v189, v208, v181, -v197
    v_fma_f32 v190, v208, v182, -v198
    v_fma_f32 v191, v208, v183, -v199
    v_cvt_pk_bf16_f32 v148, v184, v185
    v_cvt_pk_bf16_f32 v149, v186, v187
    v_cvt_pk_bf16_f32 v150, v188, v189
    v_cvt_pk_bf16_f32 v151, v190, v191
    v_fma_f32 v192, v208, v184, -v176
    v_fma_f32 v193, v208, v185, -v177
    v_fma_f32 v194, v208, v186, -v178
    v_fma_f32 v195, v208, v187, -v179
    v_fma_f32 v196, v208, v188, -v180
    v_fma_f32 v197, v208, v189, -v181
    v_fma_f32 v198, v208, v190, -v182
    v_fma_f32 v199, v208, v191, -v183
    v_cvt_pk_bf16_f32 v152, v192, v193
    v_cvt_pk_bf16_f32 v153, v194, v195
    v_cvt_pk_bf16_f32 v154, v196, v197
    v_cvt_pk_bf16_f32 v155, v198, v199
    v_fma_f32 v176, v208, v192, -v184
    v_fma_f32 v177, v208, v193, -v185
    v_fma_f32 v178, v208, v194, -v186
    v_fma_f32 v179, v208, v195, -v187
    v_fma_f32 v180, v208, v196, -v188
    v_fma_f32 v181, v208, v197, -v189
    v_fma_f32 v182, v208, v198, -v190
    v_fma_f32 v183, v208, v199, -v191
    v_cvt_pk_bf16_f32 v156, v176, v177
    v_cvt_pk_bf16_f32 v157, v178, v179
    v_cvt_pk_bf16_f32 v158, v180, v181
    v_cvt_pk_bf16_f32 v159, v182, v183
    v_fma_f32 v184, v208, v176, -v192
    v_fma_f32 v185, v208, v177, -v193
    v_fma_f32 v186, v208, v178, -v194
    v_fma_f32 v187, v208, v179, -v195
    v_fma_f32 v188, v208, v180, -v196
    v_fma_f32 v189, v208, v181, -v197
    v_fma_f32 v190, v208, v182, -v198
    v_fma_f32 v191, v208, v183, -v199
    v_cvt_pk_bf16_f32 v160, v184, v185
    v_cvt_pk_bf16_f32 v161, v186, v187
    v_cvt_pk_bf16_f32 v162, v188, v189
    v_cvt_pk_bf16_f32 v163, v190, v191
    v_fma_f32 v192, v208, v184, -v176
    v_fma_f32 v193, v208, v185, -v177
    v_fma_f32 v194, v208, v186, -v178
    v_fma_f32 v195, v208, v187, -v179
    v_fma_f32 v196, v208, v188, -v180
    v_fma_f32 v197, v208, v189, -v181
    v_fma_f32 v198, v208, v190, -v182
    v_fma_f32 v199, v208, v191, -v183
    v_cvt_pk_bf16_f32 v164, v192, v193
    v_cvt_pk_bf16_f32 v165, v194, v195
    v_cvt_pk_bf16_f32 v166, v196, v197
    v_cvt_pk_bf16_f32 v167, v198, v199
    v_fma_f32 v176, v208, v192, -v184
    v_fma_f32 v177, v208, v193, -v185
    v_fma_f32 v178, v208, v194, -v186
    v_fma_f32 v179, v208, v195, -v187
    v_fma_f32 v180, v208, v196, -v188
    v_fma_f32 v181, v208, v197, -v189
    v_fma_f32 v182, v208, v198, -v190
    v_fma_f32 v183, v208, v199, -v191
    v_cvt_pk_bf16_f32 v168, v176, v177
    v_cvt_pk_bf16_f32 v169, v178, v179
    v_cvt_pk_bf16_f32 v170, v180, v181
    v_cvt_pk_bf16_f32 v171, v182, v183
    v_fma_f32 v184, v208, v176, -v192
    v_fma_f32 v185, v208, v177, -v193
    v_fma_f32 v186, v208, v178, -v194
    v_fma_f32 v187, v208, v179, -v195
    v_fma_f32 v188, v208, v180, -v196
    v_fma_f32 v189, v208, v181, -v197
    v_fma_f32 v190, v208, v182, -v198
    v_fma_f32 v191, v208, v183, -v199
    v_cvt_pk_bf16_f32 v172, v184, v185
    v_cvt_pk_bf16_f32 v173, v186, v187
    v_cvt_pk_bf16_f32 v174, v188, v189
    v_cvt_pk_bf16_f32 v175, v190, v191
    s_add_u32 s15, s31, 4
    s_lshl_b32 s15, s15, 5
    v_and_b32 v6, 31, v2
    v_add_u32 v6, s15, v6
    v_and_b32 v7, 1, v6
    v_and_b32 v8, 0xfffffffe, v6
    v_add_u32 v8, s14, v8
    v_lshl_add_u32 v1, v8, 1, v7
    v_cmp_eq_u32 vcc, 1, v1
    v_mov_b32 v10, 320
    s_lshl_b32 s15, s12, 6
    v_cndmask_b32 v8, v8, v10, vcc
    v_cndmask_b32 v7, v7, 0, vcc
    v_lshl_add_u32 v1, v8, 1, v7
    v_lshlrev_b32 v1, 12, v1
    v_lshl_add_u32 v1, v11, 5, v1
    v_add_u32 v1, s15, v1
    v_cvt_f32_u32 v8, v8
    v_cvt_f32_u32 v7, v7
    v_lshlrev_b32 v10, 3, v11
    s_mul_i32 s15, s3, 80
    v_add_u32 v10, s15, v10
    s_lshl_b32 s15, s3, 3
    v_add_u32 v1, s15, v1
    v_cvt_f32_u32 v10, v10
    v_mul_f32 v8, 0x3acccccd, v8
    v_mul_f32 v7, 0x3e800000, v7
    v_fmac_f32 v7, v10, v8
    v_mul_f32 v208, 0x41800000, v8
    v_fmamk_f32 v176, v8, 0x00000000, v7
    v_fmamk_f32 v177, v8, 0x3f800000, v7
    v_fmamk_f32 v178, v8, 0x40000000, v7
    v_fmamk_f32 v179, v8, 0x40400000, v7
    v_fmamk_f32 v180, v8, 0x40800000, v7
    v_fmamk_f32 v181, v8, 0x40a00000, v7
    v_fmamk_f32 v182, v8, 0x40c00000, v7
    v_fmamk_f32 v183, v8, 0x40e00000, v7
    v_fmamk_f32 v184, v8, 0x41800000, v7
    v_fmamk_f32 v185, v8, 0x41880000, v7
    v_fmamk_f32 v186, v8, 0x41900000, v7
    v_fmamk_f32 v187, v8, 0x41980000, v7
    v_fmamk_f32 v188, v8, 0x41a00000, v7
    v_fmamk_f32 v189, v8, 0x41a80000, v7
    v_fmamk_f32 v190, v8, 0x41b00000, v7
    v_fmamk_f32 v191, v8, 0x41b80000, v7
    v_cos_f32 v208, v208
    v_cos_f32 v176, v176
    v_cos_f32 v177, v177
    v_cos_f32 v178, v178
    v_cos_f32 v179, v179
    v_cos_f32 v180, v180
    v_cos_f32 v181, v181
    v_cos_f32 v182, v182
    v_cos_f32 v183, v183
    v_cos_f32 v184, v184
    v_cos_f32 v185, v185
    v_cos_f32 v186, v186
    v_cos_f32 v187, v187
    v_cos_f32 v188, v188
    v_cos_f32 v189, v189
    v_cos_f32 v190, v190
    v_cos_f32 v191, v191
    v_add_f32 v208, v208, v208
    v_cvt_pk_bf16_f32 v240, v176, v177
    v_cvt_pk_bf16_f32 v241, v178, v179
    v_cvt_pk_bf16_f32 v242, v180, v181
    v_cvt_pk_bf16_f32 v243, v182, v183
    v_cvt_pk_bf16_f32 v244, v184, v185
    v_cvt_pk_bf16_f32 v245, v186, v187
    v_cvt_pk_bf16_f32 v246, v188, v189
    v_cvt_pk_bf16_f32 v247, v190, v191
    v_fma_f32 v192, v208, v184, -v176
    v_fma_f32 v193, v208, v185, -v177
    v_fma_f32 v194, v208, v186, -v178
    v_fma_f32 v195, v208, v187, -v179
    v_fma_f32 v196, v208, v188, -v180
    v_fma_f32 v197, v208, v189, -v181
    v_fma_f32 v198, v208, v190, -v182
    v_fma_f32 v199, v208, v191, -v183
    v_cvt_pk_bf16_f32 v248, v192, v193
    v_cvt_pk_bf16_f32 v249, v194, v195
    v_cvt_pk_bf16_f32 v250, v196, v197
    v_cvt_pk_bf16_f32 v251, v198, v199
    v_fma_f32 v176, v208, v192, -v184
    v_fma_f32 v177, v208, v193, -v185
    v_fma_f32 v178, v208, v194, -v186
    v_fma_f32 v179, v208, v195, -v187
    v_fma_f32 v180, v208, v196, -v188
    v_fma_f32 v181, v208, v197, -v189
    v_fma_f32 v182, v208, v198, -v190
    v_fma_f32 v183, v208, v199, -v191
    v_cvt_pk_bf16_f32 v252, v176, v177
    v_cvt_pk_bf16_f32 v253, v178, v179
    v_cvt_pk_bf16_f32 v254, v180, v181
    v_cvt_pk_bf16_f32 v255, v182, v183
    v_fma_f32 v184, v208, v176, -v192
    v_fma_f32 v185, v208, v177, -v193
    v_fma_f32 v186, v208, v178, -v194
    v_fma_f32 v187, v208, v179, -v195
    v_fma_f32 v188, v208, v180, -v196
    v_fma_f32 v189, v208, v181, -v197
    v_fma_f32 v190, v208, v182, -v198
    v_fma_f32 v191, v208, v183, -v199
    v_cvt_pk_bf16_f32 v204, v184, v185
    v_cvt_pk_bf16_f32 v205, v186, v187
    v_cvt_pk_bf16_f32 v206, v188, v189
    v_cvt_pk_bf16_f32 v207, v190, v191
    v_and_b32 v6, 31, v2
    v_add_u32 v10, 0, v11
    v_xor_b32 v10, v10, v6
    v_lshlrev_b32 v10, 4, v10
    v_lshl_add_u32 v10, v11, 9, v10
    v_add_u32 v12, 0, v10
    v_add_u32 v10, 2, v11
    v_xor_b32 v10, v10, v6
    v_lshlrev_b32 v10, 4, v10
    v_lshl_add_u32 v10, v11, 9, v10
    v_add_u32 v13, 1024, v10
    v_add_u32 v10, 4, v11
    v_xor_b32 v10, v10, v6
    v_lshlrev_b32 v10, 4, v10
    v_lshl_add_u32 v10, v11, 9, v10
    v_add_u32 v14, 2048, v10
    v_add_u32 v10, 6, v11
    v_xor_b32 v10, v10, v6
    v_lshlrev_b32 v10, 4, v10
    v_lshl_add_u32 v10, v11, 9, v10
    v_add_u32 v15, 3072, v10
    s_waitcnt vmcnt(9)
    v_lshlrev_b32 v16, 16, v20
    v_and_b32 v17, 0xffff0000, v20
    v_lshlrev_b32 v18, 16, v21
    v_and_b32 v19, 0xffff0000, v21
    v_lshlrev_b32 v20, 16, v22
    v_and_b32 v21, 0xffff0000, v22
    v_lshlrev_b32 v22, 16, v23
    v_and_b32 v23, 0xffff0000, v23
    s_waitcnt vmcnt(8)
    v_lshlrev_b32 v24, 16, v28
    v_and_b32 v25, 0xffff0000, v28
    v_lshlrev_b32 v26, 16, v29
    v_and_b32 v27, 0xffff0000, v29
    v_lshlrev_b32 v28, 16, v30
    v_and_b32 v29, 0xffff0000, v30
    v_lshlrev_b32 v30, 16, v31
    v_and_b32 v31, 0xffff0000, v31
    s_waitcnt vmcnt(7)
    v_lshlrev_b32 v32, 16, v36
    v_and_b32 v33, 0xffff0000, v36
    v_lshlrev_b32 v34, 16, v37
    v_and_b32 v35, 0xffff0000, v37
    v_lshlrev_b32 v36, 16, v38
    v_and_b32 v37, 0xffff0000, v38
    v_lshlrev_b32 v38, 16, v39
    v_and_b32 v39, 0xffff0000, v39
    s_waitcnt vmcnt(6)
    v_lshlrev_b32 v40, 16, v44
    v_and_b32 v41, 0xffff0000, v44
    v_lshlrev_b32 v42, 16, v45
    v_and_b32 v43, 0xffff0000, v45
    v_lshlrev_b32 v44, 16, v46
    v_and_b32 v45, 0xffff0000, v46
    v_lshlrev_b32 v46, 16, v47
    v_and_b32 v47, 0xffff0000, v47
    s_waitcnt vmcnt(5)
    v_lshlrev_b32 v48, 16, v52
    v_and_b32 v49, 0xffff0000, v52
    v_lshlrev_b32 v50, 16, v53
    v_and_b32 v51, 0xffff0000, v53
    v_lshlrev_b32 v52, 16, v54
    v_and_b32 v53, 0xffff0000, v54
    v_lshlrev_b32 v54, 16, v55
    v_and_b32 v55, 0xffff0000, v55
    s_waitcnt vmcnt(4)
    v_lshlrev_b32 v56, 16, v60
    v_and_b32 v57, 0xffff0000, v60
    v_lshlrev_b32 v58, 16, v61
    v_and_b32 v59, 0xffff0000, v61
    v_lshlrev_b32 v60, 16, v62
    v_and_b32 v61, 0xffff0000, v62
    v_lshlrev_b32 v62, 16, v63
    v_and_b32 v63, 0xffff0000, v63
    s_waitcnt vmcnt(3)
    v_lshlrev_b32 v64, 16, v68
    v_and_b32 v65, 0xffff0000, v68
    v_lshlrev_b32 v66, 16, v69
    v_and_b32 v67, 0xffff0000, v69
    v_lshlrev_b32 v68, 16, v70
    v_and_b32 v69, 0xffff0000, v70
    v_lshlrev_b32 v70, 16, v71
    v_and_b32 v71, 0xffff0000, v71
    s_waitcnt vmcnt(2)
    v_lshlrev_b32 v72, 16, v76
    v_and_b32 v73, 0xffff0000, v76
    v_lshlrev_b32 v74, 16, v77
    v_and_b32 v75, 0xffff0000, v77
    v_lshlrev_b32 v76, 16, v78
    v_and_b32 v77, 0xffff0000, v78
    v_lshlrev_b32 v78, 16, v79
    v_and_b32 v79, 0xffff0000, v79
    s_waitcnt vmcnt(1)
    v_lshlrev_b32 v80, 16, v84
    v_and_b32 v81, 0xffff0000, v84
    v_lshlrev_b32 v82, 16, v85
    v_and_b32 v83, 0xffff0000, v85
    v_lshlrev_b32 v84, 16, v86
    v_and_b32 v85, 0xffff0000, v86
    v_lshlrev_b32 v86, 16, v87
    v_and_b32 v87, 0xffff0000, v87
    s_waitcnt vmcnt(0)
    v_lshlrev_b32 v88, 16, v92
    v_and_b32 v89, 0xffff0000, v92
    v_lshlrev_b32 v90, 16, v93
    v_and_b32 v91, 0xffff0000, v93
    v_lshlrev_b32 v92, 16, v94
    v_and_b32 v93, 0xffff0000, v94
    v_lshlrev_b32 v94, 16, v95
    v_and_b32 v95, 0xffff0000, v95
    v_pk_add_f32 v[176:177], v[16:17], v[24:25]
    v_pk_add_f32 v[178:179], v[18:19], v[26:27]
    v_pk_add_f32 v[180:181], v[20:21], v[28:29]
    v_pk_add_f32 v[182:183], v[22:23], v[30:31]
    v_pk_add_f32 v[176:177], v[176:177], v[32:33]
    v_pk_add_f32 v[178:179], v[178:179], v[34:35]
    v_pk_add_f32 v[180:181], v[180:181], v[36:37]
    v_pk_add_f32 v[182:183], v[182:183], v[38:39]
    v_pk_add_f32 v[176:177], v[176:177], v[40:41]
    v_pk_add_f32 v[178:179], v[178:179], v[42:43]
    v_pk_add_f32 v[180:181], v[180:181], v[44:45]
    v_pk_add_f32 v[182:183], v[182:183], v[46:47]
    v_pk_add_f32 v[176:177], v[176:177], v[48:49]
    v_pk_add_f32 v[178:179], v[178:179], v[50:51]
    v_pk_add_f32 v[180:181], v[180:181], v[52:53]
    v_pk_add_f32 v[182:183], v[182:183], v[54:55]
    v_pk_add_f32 v[176:177], v[176:177], v[56:57]
    v_pk_add_f32 v[178:179], v[178:179], v[58:59]
    v_pk_add_f32 v[180:181], v[180:181], v[60:61]
    v_pk_add_f32 v[182:183], v[182:183], v[62:63]
    v_pk_add_f32 v[176:177], v[176:177], v[64:65]
    v_pk_add_f32 v[178:179], v[178:179], v[66:67]
    v_pk_add_f32 v[180:181], v[180:181], v[68:69]
    v_pk_add_f32 v[182:183], v[182:183], v[70:71]
    v_pk_add_f32 v[176:177], v[176:177], v[72:73]
    v_pk_add_f32 v[178:179], v[178:179], v[74:75]
    v_pk_add_f32 v[180:181], v[180:181], v[76:77]
    v_pk_add_f32 v[182:183], v[182:183], v[78:79]
    v_pk_add_f32 v[176:177], v[176:177], v[80:81]
    v_pk_add_f32 v[178:179], v[178:179], v[82:83]
    v_pk_add_f32 v[180:181], v[180:181], v[84:85]
    v_pk_add_f32 v[182:183], v[182:183], v[86:87]
    v_pk_add_f32 v[176:177], v[176:177], v[88:89]
    v_pk_add_f32 v[178:179], v[178:179], v[90:91]
    v_pk_add_f32 v[180:181], v[180:181], v[92:93]
    v_pk_add_f32 v[182:183], v[182:183], v[94:95]
    v_pk_add_f32 v[176:177], v[176:177], v[178:179]
    v_pk_add_f32 v[180:181], v[180:181], v[182:183]
    s_nop 0
    v_pk_add_f32 v[176:177], v[176:177], v[180:181]
    s_nop 0
    v_add_f32 v176, v176, v177
    s_nop 1
    v_add_f32_dpp v177, v176, v176 quad_perm:[1,0,3,2] row_mask:0xf bank_mask:0xf
    s_nop 1
    v_add_f32_dpp v176, v177, v177 quad_perm:[2,3,0,1] row_mask:0xf bank_mask:0xf
    s_nop 1
    v_add_f32_dpp v177, v176, v176 row_half_mirror row_mask:0xf bank_mask:0xf
    v_mul_f32 v186, 0x3acccccd, v177
    v_sub_f32 v184, 0, v186
    v_sub_f32 v185, 0, v186
    v_pk_add_f32 v[208:209], v[16:17], v[184:185]
    v_pk_add_f32 v[210:211], v[18:19], v[184:185]
    v_pk_add_f32 v[212:213], v[20:21], v[184:185]
    v_pk_add_f32 v[214:215], v[22:23], v[184:185]
    v_pk_add_f32 v[216:217], v[24:25], v[184:185]
    v_pk_mul_f32 v[176:177], v[208:209], v[208:209]
    v_pk_add_f32 v[218:219], v[26:27], v[184:185]
    v_pk_mul_f32 v[178:179], v[210:211], v[210:211]
    v_pk_add_f32 v[220:221], v[28:29], v[184:185]
    v_pk_mul_f32 v[180:181], v[212:213], v[212:213]
    v_pk_add_f32 v[222:223], v[30:31], v[184:185]
    v_pk_mul_f32 v[182:183], v[214:215], v[214:215]
    v_pk_add_f32 v[208:209], v[32:33], v[184:185]
    v_pk_fma_f32 v[176:177], v[216:217], v[216:217], v[176:177]
    v_pk_add_f32 v[210:211], v[34:35], v[184:185]
    v_pk_fma_f32 v[178:179], v[218:219], v[218:219], v[178:179]
    v_pk_add_f32 v[212:213], v[36:37], v[184:185]
    v_pk_fma_f32 v[180:181], v[220:221], v[220:221], v[180:181]
    v_pk_add_f32 v[214:215], v[38:39], v[184:185]
    v_pk_fma_f32 v[182:183], v[222:223], v[222:223], v[182:183]
    v_pk_add_f32 v[216:217], v[40:41], v[184:185]
    v_pk_fma_f32 v[176:177], v[208:209], v[208:209], v[176:177]
    v_pk_add_f32 v[218:219], v[42:43], v[184:185]
    v_pk_fma_f32 v[178:179], v[210:211], v[210:211], v[178:179]
    v_pk_add_f32 v[220:221], v[44:45], v[184:185]
    v_pk_fma_f32 v[180:181], v[212:213], v[212:213], v[180:181]
    v_pk_add_f32 v[222:223], v[46:47], v[184:185]
    v_pk_fma_f32 v[182:183], v[214:215], v[214:215], v[182:183]
    v_pk_add_f32 v[208:209], v[48:49], v[184:185]
    v_pk_fma_f32 v[176:177], v[216:217], v[216:217], v[176:177]
    v_pk_add_f32 v[210:211], v[50:51], v[184:185]
    v_pk_fma_f32 v[178:179], v[218:219], v[218:219], v[178:179]
    v_pk_add_f32 v[212:213], v[52:53], v[184:185]
    v_pk_fma_f32 v[180:181], v[220:221], v[220:221], v[180:181]
    v_pk_add_f32 v[214:215], v[54:55], v[184:185]
    v_pk_fma_f32 v[182:183], v[222:223], v[222:223], v[182:183]
    v_pk_add_f32 v[216:217], v[56:57], v[184:185]
    v_pk_fma_f32 v[176:177], v[208:209], v[208:209], v[176:177]
    v_pk_add_f32 v[218:219], v[58:59], v[184:185]
    v_pk_fma_f32 v[178:179], v[210:211], v[210:211], v[178:179]
    v_pk_add_f32 v[220:221], v[60:61], v[184:185]
    v_pk_fma_f32 v[180:181], v[212:213], v[212:213], v[180:181]
    v_pk_add_f32 v[222:223], v[62:63], v[184:185]
    v_pk_fma_f32 v[182:183], v[214:215], v[214:215], v[182:183]
    v_pk_add_f32 v[208:209], v[64:65], v[184:185]
    v_pk_fma_f32 v[176:177], v[216:217], v[216:217], v[176:177]
    v_pk_add_f32 v[210:211], v[66:67], v[184:185]
    v_pk_fma_f32 v[178:179], v[218:219], v[218:219], v[178:179]
    v_pk_add_f32 v[212:213], v[68:69], v[184:185]
    v_pk_fma_f32 v[180:181], v[220:221], v[220:221], v[180:181]
    v_pk_add_f32 v[214:215], v[70:71], v[184:185]
    v_pk_fma_f32 v[182:183], v[222:223], v[222:223], v[182:183]
    v_pk_add_f32 v[216:217], v[72:73], v[184:185]
    v_pk_fma_f32 v[176:177], v[208:209], v[208:209], v[176:177]
    v_pk_add_f32 v[218:219], v[74:75], v[184:185]
    v_pk_fma_f32 v[178:179], v[210:211], v[210:211], v[178:179]
    v_pk_add_f32 v[220:221], v[76:77], v[184:185]
    v_pk_fma_f32 v[180:181], v[212:213], v[212:213], v[180:181]
    v_pk_add_f32 v[222:223], v[78:79], v[184:185]
    v_pk_fma_f32 v[182:183], v[214:215], v[214:215], v[182:183]
    v_pk_add_f32 v[208:209], v[80:81], v[184:185]
    v_pk_fma_f32 v[176:177], v[216:217], v[216:217], v[176:177]
    v_pk_add_f32 v[210:211], v[82:83], v[184:185]
    v_pk_fma_f32 v[178:179], v[218:219], v[218:219], v[178:179]
    v_pk_add_f32 v[212:213], v[84:85], v[184:185]
    v_pk_fma_f32 v[180:181], v[220:221], v[220:221], v[180:181]
    v_pk_add_f32 v[214:215], v[86:87], v[184:185]
    v_pk_fma_f32 v[182:183], v[222:223], v[222:223], v[182:183]
    v_pk_add_f32 v[216:217], v[88:89], v[184:185]
    v_pk_fma_f32 v[176:177], v[208:209], v[208:209], v[176:177]
    v_pk_add_f32 v[218:219], v[90:91], v[184:185]
    v_pk_fma_f32 v[178:179], v[210:211], v[210:211], v[178:179]
    v_pk_add_f32 v[220:221], v[92:93], v[184:185]
    v_pk_fma_f32 v[180:181], v[212:213], v[212:213], v[180:181]
    v_pk_add_f32 v[222:223], v[94:95], v[184:185]
    v_pk_fma_f32 v[182:183], v[214:215], v[214:215], v[182:183]
    v_pk_fma_f32 v[176:177], v[216:217], v[216:217], v[176:177]
    v_pk_fma_f32 v[178:179], v[218:219], v[218:219], v[178:179]
    v_pk_fma_f32 v[180:181], v[220:221], v[220:221], v[180:181]
    v_pk_fma_f32 v[182:183], v[222:223], v[222:223], v[182:183]
    v_pk_add_f32 v[176:177], v[176:177], v[178:179]
    v_pk_add_f32 v[180:181], v[180:181], v[182:183]
    s_nop 0
    v_pk_add_f32 v[176:177], v[176:177], v[180:181]
    s_nop 0
    v_add_f32 v176, v176, v177
    s_nop 1
    v_add_f32_dpp v177, v176, v176 quad_perm:[1,0,3,2] row_mask:0xf bank_mask:0xf
    s_nop 1
    v_add_f32_dpp v176, v177, v177 quad_perm:[2,3,0,1] row_mask:0xf bank_mask:0xf
    s_nop 1
    v_add_f32_dpp v177, v176, v176 row_half_mirror row_mask:0xf bank_mask:0xf
    v_mul_f32 v187, 0x3acccccd, v177
    v_cvt_pk_bf16_f32 v188, v186, v186
    v_and_b32 v188, 0xffff0000, v188
    v_cvt_pk_bf16_f32 v190, v187, v187
    v_and_b32 v190, 0xffff0000, v190
    v_add_f32 v190, 0x3727c5ac, v190
    v_cvt_pk_bf16_f32 v190, v190, v190
    v_and_b32 v190, 0xffff0000, v190
    v_sqrt_f32 v190, v190
    s_nop 0
    v_cvt_pk_bf16_f32 v190, v190, v190
    v_and_b32 v190, 0xffff0000, v190
    v_rcp_f32 v190, v190
    s_nop 0
    v_mov_b32 v191, v190
    v_mul_f32 v192, v188, v190
    v_sub_f32 v196, v186, v188
    v_mul_f32 v196, v196, v190
    v_mul_f32 v197, v187, v190
    v_mul_f32 v197, v197, v190
    v_mov_b32 v202, v192
    s_cmp_eq_u32 s14, 0
    s_cselect_b32 s28, -2.0, 0
    s_cselect_b32 s30, 1.0, -1.0
    s_mov_b32 s31, s30
    v_mul_f32 v192, s28, v192
    v_mov_b32 v193, v192
    v_lshlrev_b32 v10, 9, v4
    v_xor_b32 v6, v3, v4
    v_lshl_add_u32 v6, v6, 4, v10
    v_pk_fma_f32 v[208:209], v[56:57], s[30:31], v[16:17]
    v_pk_fma_f32 v[210:211], v[58:59], s[30:31], v[18:19]
    v_pk_fma_f32 v[212:213], v[60:61], s[30:31], v[20:21]
    v_pk_fma_f32 v[214:215], v[62:63], s[30:31], v[22:23]
    v_pk_fma_f32 v[208:209], v[208:209], v[190:191], v[192:193]
    v_pk_fma_f32 v[210:211], v[210:211], v[190:191], v[192:193]
    v_pk_fma_f32 v[212:213], v[212:213], v[190:191], v[192:193]
    v_pk_fma_f32 v[214:215], v[214:215], v[190:191], v[192:193]
    v_cvt_pk_bf16_f32 v216, v208, v209
    v_cvt_pk_bf16_f32 v217, v210, v211
    v_cvt_pk_bf16_f32 v218, v212, v213
    v_cvt_pk_bf16_f32 v219, v214, v215
    ds_write_b128 v6, v[216:219] offset:0
    v_pk_fma_f32 v[224:225], v[64:65], s[30:31], v[24:25]
    v_pk_fma_f32 v[226:227], v[66:67], s[30:31], v[26:27]
    v_pk_fma_f32 v[228:229], v[68:69], s[30:31], v[28:29]
    v_pk_fma_f32 v[230:231], v[70:71], s[30:31], v[30:31]
    v_pk_fma_f32 v[224:225], v[224:225], v[190:191], v[192:193]
    v_pk_fma_f32 v[226:227], v[226:227], v[190:191], v[192:193]
    v_pk_fma_f32 v[228:229], v[228:229], v[190:191], v[192:193]
    v_pk_fma_f32 v[230:231], v[230:231], v[190:191], v[192:193]
    v_cvt_pk_bf16_f32 v232, v224, v225
    v_cvt_pk_bf16_f32 v233, v226, v227
    v_cvt_pk_bf16_f32 v234, v228, v229
    v_cvt_pk_bf16_f32 v235, v230, v231
    ds_write_b128 v6, v[232:235] offset:4096
    v_pk_fma_f32 v[208:209], v[72:73], s[30:31], v[32:33]
    v_pk_fma_f32 v[210:211], v[74:75], s[30:31], v[34:35]
    v_pk_fma_f32 v[212:213], v[76:77], s[30:31], v[36:37]
    v_pk_fma_f32 v[214:215], v[78:79], s[30:31], v[38:39]
    v_pk_fma_f32 v[208:209], v[208:209], v[190:191], v[192:193]
    v_pk_fma_f32 v[210:211], v[210:211], v[190:191], v[192:193]
    v_pk_fma_f32 v[212:213], v[212:213], v[190:191], v[192:193]
    v_pk_fma_f32 v[214:215], v[214:215], v[190:191], v[192:193]
    v_cvt_pk_bf16_f32 v216, v208, v209
    v_cvt_pk_bf16_f32 v217, v210, v211
    v_cvt_pk_bf16_f32 v218, v212, v213
    v_cvt_pk_bf16_f32 v219, v214, v215
    ds_write_b128 v6, v[216:219] offset:8192
    v_pk_fma_f32 v[224:225], v[80:81], s[30:31], v[40:41]
    v_pk_fma_f32 v[226:227], v[82:83], s[30:31], v[42:43]
    v_pk_fma_f32 v[228:229], v[84:85], s[30:31], v[44:45]
    v_pk_fma_f32 v[230:231], v[86:87], s[30:31], v[46:47]
    v_pk_fma_f32 v[224:225], v[224:225], v[190:191], v[192:193]
    v_pk_fma_f32 v[226:227], v[226:227], v[190:191], v[192:193]
    v_pk_fma_f32 v[228:229], v[228:229], v[190:191], v[192:193]
    v_pk_fma_f32 v[230:231], v[230:231], v[190:191], v[192:193]
    v_cvt_pk_bf16_f32 v232, v224, v225
    v_cvt_pk_bf16_f32 v233, v226, v227
    v_cvt_pk_bf16_f32 v234, v228, v229
    v_cvt_pk_bf16_f32 v235, v230, v231
    ds_write_b128 v6, v[232:235] offset:12288
    v_pk_fma_f32 v[208:209], v[88:89], s[30:31], v[48:49]
    v_pk_fma_f32 v[210:211], v[90:91], s[30:31], v[50:51]
    v_pk_fma_f32 v[212:213], v[92:93], s[30:31], v[52:53]
    v_pk_fma_f32 v[214:215], v[94:95], s[30:31], v[54:55]
    v_pk_fma_f32 v[208:209], v[208:209], v[190:191], v[192:193]
    v_pk_fma_f32 v[210:211], v[210:211], v[190:191], v[192:193]
    v_pk_fma_f32 v[212:213], v[212:213], v[190:191], v[192:193]
    v_pk_fma_f32 v[214:215], v[214:215], v[190:191], v[192:193]
    v_cvt_pk_bf16_f32 v216, v208, v209
    v_cvt_pk_bf16_f32 v217, v210, v211
    v_cvt_pk_bf16_f32 v218, v212, v213
    v_cvt_pk_bf16_f32 v219, v214, v215
    ds_write_b128 v6, v[216:219] offset:16384
    v_cvt_pk_bf16_f32 v196, v196, v196
    v_and_b32 v196, 0xffff0000, v196
    v_cvt_pk_bf16_f32 v198, v197, v197
    v_and_b32 v198, 0xffff0000, v198
    v_add_f32 v198, 0x3727c5ac, v198
    v_cvt_pk_bf16_f32 v198, v198, v198
    v_and_b32 v198, 0xffff0000, v198
    v_sqrt_f32 v198, v198
    s_nop 0
    v_cvt_pk_bf16_f32 v198, v198, v198
    v_and_b32 v198, 0xffff0000, v198
    v_rcp_f32 v198, v198
    s_nop 0
    v_add_f32 v202, v202, v196
    v_mul_f32 v200, v190, v198
    v_mul_f32 v202, v202, v198
    v_mov_b32 v201, v200
    v_sub_f32 v202, 0, v202
    v_lshl_add_u32 v10, v3, 4, v10
    v_mov_b32 v203, v202
    s_mul_i32 s15, s12, 40960
    s_cmp_lg_u32 s13, 0
    s_cbranch_scc1 K1_Y1
    v_pk_fma_f32 v[208:209], v[16:17], v[200:201], v[202:203]
    v_pk_fma_f32 v[210:211], v[18:19], v[200:201], v[202:203]
    v_pk_fma_f32 v[212:213], v[20:21], v[200:201], v[202:203]
    v_pk_fma_f32 v[214:215], v[22:23], v[200:201], v[202:203]
    v_pk_fma_f32 v[216:217], v[24:25], v[200:201], v[202:203]
    v_pk_fma_f32 v[218:219], v[26:27], v[200:201], v[202:203]
    v_pk_fma_f32 v[220:221], v[28:29], v[200:201], v[202:203]
    v_pk_fma_f32 v[222:223], v[30:31], v[200:201], v[202:203]
    v_pk_fma_f32 v[224:225], v[32:33], v[200:201], v[202:203]
    v_pk_fma_f32 v[226:227], v[34:35], v[200:201], v[202:203]
    v_pk_fma_f32 v[228:229], v[36:37], v[200:201], v[202:203]
    v_pk_fma_f32 v[230:231], v[38:39], v[200:201], v[202:203]
    s_add_u32 s15, s15, 0
    v_cvt_pk_bf16_f32 v208, v208, v209
    v_cvt_pk_bf16_f32 v209, v210, v211
    v_cvt_pk_bf16_f32 v210, v212, v213
    v_cvt_pk_bf16_f32 v211, v214, v215
    buffer_store_dwordx4 v[208:211], v10, s[24:27], s15 offen
    s_add_u32 s15, s15, 4096
    v_cvt_pk_bf16_f32 v216, v216, v217
    v_cvt_pk_bf16_f32 v217, v218, v219
    v_cvt_pk_bf16_f32 v218, v220, v221
    v_cvt_pk_bf16_f32 v219, v222, v223
    buffer_store_dwordx4 v[216:219], v10, s[24:27], s15 offen
    s_add_u32 s15, s15, 4096
    v_cvt_pk_bf16_f32 v224, v224, v225
    v_cvt_pk_bf16_f32 v225, v226, v227
    v_cvt_pk_bf16_f32 v226, v228, v229
    v_cvt_pk_bf16_f32 v227, v230, v231
    buffer_store_dwordx4 v[224:227], v10, s[24:27], s15 offen
    s_branch K1_YS
K1_Y1:
    s_cmp_lg_u32 s13, 1
    s_cbranch_scc1 K1_Y2
    v_pk_fma_f32 v[208:209], v[40:41], v[200:201], v[202:203]
    v_pk_fma_f32 v[210:211], v[42:43], v[200:201], v[202:203]
    v_pk_fma_f32 v[212:213], v[44:45], v[200:201], v[202:203]
    v_pk_fma_f32 v[214:215], v[46:47], v[200:201], v[202:203]
    v_pk_fma_f32 v[216:217], v[48:49], v[200:201], v[202:203]
    v_pk_fma_f32 v[218:219], v[50:51], v[200:201], v[202:203]
    v_pk_fma_f32 v[220:221], v[52:53], v[200:201], v[202:203]
    v_pk_fma_f32 v[222:223], v[54:55], v[200:201], v[202:203]
    v_pk_fma_f32 v[224:225], v[56:57], v[200:201], v[202:203]
    v_pk_fma_f32 v[226:227], v[58:59], v[200:201], v[202:203]
    v_pk_fma_f32 v[228:229], v[60:61], v[200:201], v[202:203]
    v_pk_fma_f32 v[230:231], v[62:63], v[200:201], v[202:203]
    s_add_u32 s15, s15, 12288
    v_cvt_pk_bf16_f32 v208, v208, v209
    v_cvt_pk_bf16_f32 v209, v210, v211
    v_cvt_pk_bf16_f32 v210, v212, v213
    v_cvt_pk_bf16_f32 v211, v214, v215
    buffer_store_dwordx4 v[208:211], v10, s[24:27], s15 offen
    s_add_u32 s15, s15, 4096
    v_cvt_pk_bf16_f32 v216, v216, v217
    v_cvt_pk_bf16_f32 v217, v218, v219
    v_cvt_pk_bf16_f32 v218, v220, v221
    v_cvt_pk_bf16_f32 v219, v222, v223
    buffer_store_dwordx4 v[216:219], v10, s[24:27], s15 offen
    s_add_u32 s15, s15, 4096
    v_cvt_pk_bf16_f32 v224, v224, v225
    v_cvt_pk_bf16_f32 v225, v226, v227
    v_cvt_pk_bf16_f32 v226, v228, v229
    v_cvt_pk_bf16_f32 v227, v230, v231
    buffer_store_dwordx4 v[224:227], v10, s[24:27], s15 offen
    s_branch K1_YS
K1_Y2:
    s_cmp_lg_u32 s13, 2
    s_cbranch_scc1 K1_Y3
    v_pk_fma_f32 v[208:209], v[64:65], v[200:201], v[202:203]
    v_pk_fma_f32 v[210:211], v[66:67], v[200:201], v[202:203]
    v_pk_fma_f32 v[212:213], v[68:69], v[200:201], v[202:203]
    v_pk_fma_f32 v[214:215], v[70:71], v[200:201], v[202:203]
    v_pk_fma_f32 v[216:217], v[72:73], v[200:201], v[202:203]
    v_pk_fma_f32 v[218:219], v[74:75], v[200:201], v[202:203]
    v_pk_fma_f32 v[220:221], v[76:77], v[200:201], v[202:203]
    v_pk_fma_f32 v[222:223], v[78:79], v[200:201], v[202:203]
    s_add_u32 s15, s15, 24576
    v_cvt_pk_bf16_f32 v208, v208, v209
    v_cvt_pk_bf16_f32 v209, v210, v211
    v_cvt_pk_bf16_f32 v210, v212, v213
    v_cvt_pk_bf16_f32 v211, v214, v215
    buffer_store_dwordx4 v[208:211], v10, s[24:27], s15 offen
    s_add_u32 s15, s15, 4096
    v_cvt_pk_bf16_f32 v216, v216, v217
    v_cvt_pk_bf16_f32 v217, v218, v219
    v_cvt_pk_bf16_f32 v218, v220, v221
    v_cvt_pk_bf16_f32 v219, v222, v223
    buffer_store_dwordx4 v[216:219], v10, s[24:27], s15 offen
    s_branch K1_YS
K1_Y3:
    v_pk_fma_f32 v[208:209], v[80:81], v[200:201], v[202:203]
    v_pk_fma_f32 v[210:211], v[82:83], v[200:201], v[202:203]
    v_pk_fma_f32 v[212:213], v[84:85], v[200:201], v[202:203]
    v_pk_fma_f32 v[214:215], v[86:87], v[200:201], v[202:203]
    v_pk_fma_f32 v[216:217], v[88:89], v[200:201], v[202:203]
    v_pk_fma_f32 v[218:219], v[90:91], v[200:201], v[202:203]
    v_pk_fma_f32 v[220:221], v[92:93], v[200:201], v[202:203]
    v_pk_fma_f32 v[222:223], v[94:95], v[200:201], v[202:203]
    s_add_u32 s15, s15, 32768
    v_cvt_pk_bf16_f32 v208, v208, v209
    v_cvt_pk_bf16_f32 v209, v210, v211
    v_cvt_pk_bf16_f32 v210, v212, v213
    v_cvt_pk_bf16_f32 v211, v214, v215
    buffer_store_dwordx4 v[208:211], v10, s[24:27], s15 offen
    s_add_u32 s15, s15, 4096
    v_cvt_pk_bf16_f32 v216, v216, v217
    v_cvt_pk_bf16_f32 v217, v218, v219
    v_cvt_pk_bf16_f32 v218, v220, v221
    v_cvt_pk_bf16_f32 v219, v222, v223
    buffer_store_dwordx4 v[216:219], v10, s[24:27], s15 offen
K1_YS:
    v_and_b32 v6, 31, v2
    s_mul_i32 s28, s3, 5
    s_and_b32 s29, s28, 3
    s_lshl_b32 s30, s29, 1
    v_add_u32 v7, s30, v11
    v_xor_b32 v7, v7, v6
    v_lshlrev_b32 v7, 4, v7
    v_lshl_add_u32 v7, v11, 9, v7
    s_lshl_b32 s30, s28, 10
    v_add_u32 v176, s30, v7
    s_add_u32 s28, s28, 1
    s_and_b32 s29, s28, 3
    s_lshl_b32 s30, s29, 1
    v_add_u32 v7, s30, v11
    v_xor_b32 v7, v7, v6
    v_lshlrev_b32 v7, 4, v7
    v_lshl_add_u32 v7, v11, 9, v7
    s_lshl_b32 s30, s28, 10
    v_add_u32 v177, s30, v7
    s_add_u32 s28, s28, 1
    s_and_b32 s29, s28, 3
    s_lshl_b32 s30, s29, 1
    v_add_u32 v7, s30, v11
    v_xor_b32 v7, v7, v6
    v_lshlrev_b32 v7, 4, v7
    v_lshl_add_u32 v7, v11, 9, v7
    s_lshl_b32 s30, s28, 10
    v_add_u32 v178, s30, v7
    s_add_u32 s28, s28, 1
    s_and_b32 s29, s28, 3
    s_lshl_b32 s30, s29, 1
    v_add_u32 v7, s30, v11
    v_xor_b32 v7, v7, v6
    v_lshlrev_b32 v7, 4, v7
    v_lshl_add_u32 v7, v11, 9, v7
    s_lshl_b32 s30, s28, 10
    v_add_u32 v179, s30, v7
    s_add_u32 s28, s28, 1
    s_and_b32 s29, s28, 3
    s_lshl_b32 s30, s29, 1
    v_add_u32 v7, s30, v11
    v_xor_b32 v7, v7, v6
    v_lshlrev_b32 v7, 4, v7
    v_lshl_add_u32 v7, v11, 9, v7
    s_lshl_b32 s30, s28, 10
    v_add_u32 v180, s30, v7
    s_add_u32 s28, s28, 1
    v_lshlrev_b32 v7, 4, v2
    s_lshl_b32 s28, s3, 10
    s_add_u32 s28, s28, 20480
    v_add_u32 v181, s28, v7
    s_lshl_b32 s28, s3, 12
    s_add_u32 s28, s28, 20480
    v_add_u32 v182, s28, v7
    s_waitcnt lgkmcnt(0)
    s_barrier
    ds_read_b128 v[184:187], v176
    ds_read_b128 v[188:191], v177
    ds_read_b128 v[192:195], v178
    ds_read_b128 v[196:199], v179
    ds_read_b128 v[200:203], v180
    ds_read_b128 v[16:19], v12 offset:0
    ds_read_b128 v[20:23], v13 offset:0
    ds_read_b128 v[24:27], v14 offset:0
    ds_read_b128 v[28:31], v15 offset:0
    ds_read_b128 v[32:35], v12 offset:4096
    ds_read_b128 v[36:39], v13 offset:4096
    ds_read_b128 v[40:43], v14 offset:4096
    ds_read_b128 v[44:47], v15 offset:4096
    ds_read_b128 v[48:51], v12 offset:8192
    ds_read_b128 v[52:55], v13 offset:8192
    ds_read_b128 v[56:59], v14 offset:8192
    ds_read_b128 v[60:63], v15 offset:8192
    ds_read_b128 v[64:67], v12 offset:12288
    ds_read_b128 v[68:71], v13 offset:12288
    ds_read_b128 v[72:75], v14 offset:12288
    ds_read_b128 v[76:79], v15 offset:12288
    ds_read_b128 v[80:83], v12 offset:16384
    ds_read_b128 v[84:87], v13 offset:16384
    ds_read_b128 v[88:91], v14 offset:16384
    ds_read_b128 v[92:95], v15 offset:16384
    s_waitcnt lgkmcnt(15)
    v_mfma_f32_32x32x16_bf16 v[224:239], v[184:187], v[240:243], 0
    v_mfma_f32_32x32x16_bf16 v[208:223], v[16:19], v[96:99], 0
    v_mfma_f32_32x32x16_bf16 v[224:239], v[188:191], v[244:247], v[224:239]
    v_mfma_f32_32x32x16_bf16 v[208:223], v[20:23], v[100:103], v[208:223]
    v_mfma_f32_32x32x16_bf16 v[224:239], v[192:195], v[248:251], v[224:239]
    v_mfma_f32_32x32x16_bf16 v[208:223], v[24:27], v[104:107], v[208:223]
    v_mfma_f32_32x32x16_bf16 v[224:239], v[196:199], v[252:255], v[224:239]
    v_mfma_f32_32x32x16_bf16 v[208:223], v[28:31], v[108:111], v[208:223]
    v_mfma_f32_32x32x16_bf16 v[224:239], v[200:203], v[204:207], v[224:239]
    v_mfma_f32_32x32x16_bf16 v[208:223], v[32:35], v[112:115], v[208:223]
    s_waitcnt lgkmcnt(14)
    v_mfma_f32_32x32x16_bf16 v[208:223], v[36:39], v[116:119], v[208:223]
    s_waitcnt lgkmcnt(13)
    v_mfma_f32_32x32x16_bf16 v[208:223], v[40:43], v[120:123], v[208:223]
    s_waitcnt lgkmcnt(12)
    v_mfma_f32_32x32x16_bf16 v[208:223], v[44:47], v[124:127], v[208:223]
    s_waitcnt lgkmcnt(11)
    v_mfma_f32_32x32x16_bf16 v[208:223], v[48:51], v[128:131], v[208:223]
    s_waitcnt lgkmcnt(10)
    v_mfma_f32_32x32x16_bf16 v[208:223], v[52:55], v[132:135], v[208:223]
    ds_write_b128 v181, v[224:227] offset:0
    s_waitcnt lgkmcnt(10)
    v_mfma_f32_32x32x16_bf16 v[208:223], v[56:59], v[136:139], v[208:223]
    ds_write_b128 v181, v[228:231] offset:4096
    s_waitcnt lgkmcnt(10)
    v_mfma_f32_32x32x16_bf16 v[208:223], v[60:63], v[140:143], v[208:223]
    ds_write_b128 v181, v[232:235] offset:8192
    s_waitcnt lgkmcnt(10)
    v_mfma_f32_32x32x16_bf16 v[208:223], v[64:67], v[144:147], v[208:223]
    ds_write_b128 v181, v[236:239] offset:12288
    s_waitcnt lgkmcnt(10)
    v_mfma_f32_32x32x16_bf16 v[208:223], v[68:71], v[148:151], v[208:223]
    s_waitcnt lgkmcnt(9)
    v_mfma_f32_32x32x16_bf16 v[208:223], v[72:75], v[152:155], v[208:223]
    s_waitcnt lgkmcnt(8)
    v_mfma_f32_32x32x16_bf16 v[208:223], v[76:79], v[156:159], v[208:223]
    s_waitcnt lgkmcnt(7)
    v_mfma_f32_32x32x16_bf16 v[208:223], v[80:83], v[160:163], v[208:223]
    s_waitcnt lgkmcnt(6)
    v_mfma_f32_32x32x16_bf16 v[208:223], v[84:87], v[164:167], v[208:223]
    s_waitcnt lgkmcnt(5)
    v_mfma_f32_32x32x16_bf16 v[208:223], v[88:91], v[168:171], v[208:223]
    s_waitcnt lgkmcnt(4)
    v_mfma_f32_32x32x16_bf16 v[208:223], v[92:95], v[172:175], v[208:223]
    s_waitcnt lgkmcnt(0)
    s_barrier
    ds_read_b128 v[184:187], v182 offset:0
    ds_read_b128 v[188:191], v182 offset:1024
    ds_read_b128 v[192:195], v182 offset:2048
    ds_read_b128 v[196:199], v182 offset:3072
    s_nop 7
    v_cvt_pk_bf16_f32 v16, v208, v209
    v_cvt_pk_bf16_f32 v17, v210, v211
    v_cvt_pk_bf16_f32 v18, v212, v213
    v_cvt_pk_bf16_f32 v19, v214, v215
    v_cvt_pk_bf16_f32 v20, v216, v217
    v_cvt_pk_bf16_f32 v21, v218, v219
    v_cvt_pk_bf16_f32 v22, v220, v221
    v_cvt_pk_bf16_f32 v23, v222, v223
    buffer_store_dwordx4 v[16:19], v9, s[20:23], 0 offen
    buffer_store_dwordx4 v[20:23], v9, s[20:23], 0 offen offset:16
    s_waitcnt lgkmcnt(0)
    v_pk_add_f32 v[184:185], v[184:185], v[188:189]
    v_pk_add_f32 v[192:193], v[192:193], v[196:197]
    v_pk_add_f32 v[186:187], v[186:187], v[190:191]
    v_pk_add_f32 v[194:195], v[194:195], v[198:199]
    v_pk_add_f32 v[184:185], v[184:185], v[192:193]
    v_pk_add_f32 v[186:187], v[186:187], v[194:195]
    s_nop 0
    v_cvt_pk_bf16_f32 v188, v184, v185
    v_cvt_pk_bf16_f32 v189, v186, v187
    buffer_store_dwordx2 v[188:189], v1, s[20:23], 0 offen
    s_endpgm
K1_TR:
    s_cmp_ge_u32 s2, 352
    s_cbranch_scc1 K1_PF
    s_sub_u32 s12, s2, 256
    s_and_b32 s13, s12, 15
    s_lshr_b32 s12, s12, 4
    s_mul_i32 s12, s12, 54
    v_add_u32 v3, s12, v2
    v_lshlrev_b32 v3, 1, v3
    s_lshl_b32 s14, s13, 4
    s_add_u32 s14, s14, s3
    s_mul_i32 s14, s14, 5136
    s_waitcnt lgkmcnt(0)
    s_mov_b32 s16, s6
    s_mov_b32 s17, s7
    s_mov_b32 s18, 0x141000
    s_mov_b32 s19, 0x00020000
    s_mov_b32 s20, s8
    s_mov_b32 s21, s9
    s_mov_b32 s22, 0x141000
    s_mov_b32 s23, 0x00020000
    s_add_u32 s24, s10, 0x300000
    s_addc_u32 s25, s11, 0
    s_mov_b32 s26, 0x282000
    s_mov_b32 s27, 0x00020000
    s_add_u32 s15, s14, 0
    buffer_load_ushort v16, v3, s[16:19], s15 offen
    buffer_load_ushort v48, v3, s[20:23], s15 offen
    s_add_u32 s15, s14, 20544
    buffer_load_ushort v17, v3, s[16:19], s15 offen
    buffer_load_ushort v49, v3, s[20:23], s15 offen
    s_add_u32 s15, s14, 41088
    buffer_load_ushort v18, v3, s[16:19], s15 offen
    buffer_load_ushort v50, v3, s[20:23], s15 offen
    s_add_u32 s15, s14, 61632
    buffer_load_ushort v19, v3, s[16:19], s15 offen
    buffer_load_ushort v51, v3, s[20:23], s15 offen
    s_add_u32 s15, s14, 642
    buffer_load_ushort v20, v3, s[16:19], s15 offen
    buffer_load_ushort v52, v3, s[20:23], s15 offen
    s_add_u32 s15, s14, 21186
    buffer_load_ushort v21, v3, s[16:19], s15 offen
    buffer_load_ushort v53, v3, s[20:23], s15 offen
    s_add_u32 s15, s14, 41730
    buffer_load_ushort v22, v3, s[16:19], s15 offen
    buffer_load_ushort v54, v3, s[20:23], s15 offen
    s_add_u32 s15, s14, 62274
    buffer_load_ushort v23, v3, s[16:19], s15 offen
    buffer_load_ushort v55, v3, s[20:23], s15 offen
    s_add_u32 s15, s14, 1284
    buffer_load_ushort v24, v3, s[16:19], s15 offen
    buffer_load_ushort v56, v3, s[20:23], s15 offen
    s_add_u32 s15, s14, 21828
    buffer_load_ushort v25, v3, s[16:19], s15 offen
    buffer_load_ushort v57, v3, s[20:23], s15 offen
    s_add_u32 s15, s14, 42372
    buffer_load_ushort v26, v3, s[16:19], s15 offen
    buffer_load_ushort v58, v3, s[20:23], s15 offen
    s_add_u32 s15, s14, 62916
    buffer_load_ushort v27, v3, s[16:19], s15 offen
    buffer_load_ushort v59, v3, s[20:23], s15 offen
    s_add_u32 s15, s14, 1926
    buffer_load_ushort v28, v3, s[16:19], s15 offen
    buffer_load_ushort v60, v3, s[20:23], s15 offen
    s_add_u32 s15, s14, 22470
    buffer_load_ushort v29, v3, s[16:19], s15 offen
    buffer_load_ushort v61, v3, s[20:23], s15 offen
    s_add_u32 s15, s14, 43014
    buffer_load_ushort v30, v3, s[16:19], s15 offen
    buffer_load_ushort v62, v3, s[20:23], s15 offen
    s_add_u32 s15, s14, 63558
    buffer_load_ushort v31, v3, s[16:19], s15 offen
    buffer_load_ushort v63, v3, s[20:23], s15 offen
    s_add_u32 s15, s14, 2568
    buffer_load_ushort v32, v3, s[16:19], s15 offen
    buffer_load_ushort v64, v3, s[20:23], s15 offen
    s_add_u32 s15, s14, 23112
    buffer_load_ushort v33, v3, s[16:19], s15 offen
    buffer_load_ushort v65, v3, s[20:23], s15 offen
    s_add_u32 s15, s14, 43656
    buffer_load_ushort v34, v3, s[16:19], s15 offen
    buffer_load_ushort v66, v3, s[20:23], s15 offen
    s_add_u32 s15, s14, 64200
    buffer_load_ushort v35, v3, s[16:19], s15 offen
    buffer_load_ushort v67, v3, s[20:23], s15 offen
    s_add_u32 s15, s14, 3210
    buffer_load_ushort v36, v3, s[16:19], s15 offen
    buffer_load_ushort v68, v3, s[20:23], s15 offen
    s_add_u32 s15, s14, 23754
    buffer_load_ushort v37, v3, s[16:19], s15 offen
    buffer_load_ushort v69, v3, s[20:23], s15 offen
    s_add_u32 s15, s14, 44298
    buffer_load_ushort v38, v3, s[16:19], s15 offen
    buffer_load_ushort v70, v3, s[20:23], s15 offen
    s_add_u32 s15, s14, 64842
    buffer_load_ushort v39, v3, s[16:19], s15 offen
    buffer_load_ushort v71, v3, s[20:23], s15 offen
    s_add_u32 s15, s14, 3852
    buffer_load_ushort v40, v3, s[16:19], s15 offen
    buffer_load_ushort v72, v3, s[20:23], s15 offen
    s_add_u32 s15, s14, 24396
    buffer_load_ushort v41, v3, s[16:19], s15 offen
    buffer_load_ushort v73, v3, s[20:23], s15 offen
    s_add_u32 s15, s14, 44940
    buffer_load_ushort v42, v3, s[16:19], s15 offen
    buffer_load_ushort v74, v3, s[20:23], s15 offen
    s_add_u32 s15, s14, 65484
    buffer_load_ushort v43, v3, s[16:19], s15 offen
    buffer_load_ushort v75, v3, s[20:23], s15 offen
    s_add_u32 s15, s14, 4494
    buffer_load_ushort v44, v3, s[16:19], s15 offen
    buffer_load_ushort v76, v3, s[20:23], s15 offen
    s_add_u32 s15, s14, 25038
    buffer_load_ushort v45, v3, s[16:19], s15 offen
    buffer_load_ushort v77, v3, s[20:23], s15 offen
    s_add_u32 s15, s14, 45582
    buffer_load_ushort v46, v3, s[16:19], s15 offen
    buffer_load_ushort v78, v3, s[20:23], s15 offen
    s_add_u32 s15, s14, 66126
    buffer_load_ushort v47, v3, s[16:19], s15 offen
    buffer_load_ushort v79, v3, s[20:23], s15 offen
    v_mul_u32_u24 v4, 528, v2
    s_lshl_b32 s15, s3, 7
    v_add_u32 v4, s15, v4
    v_lshrrev_b32 v7, 5, v0
    v_and_b32 v8, 31, v0
    v_mul_u32_u24 v5, 528, v7
    v_lshl_add_u32 v5, v8, 4, v5
    v_add_u32 v7, s12, v7
    v_lshlrev_b32 v6, 13, v7
    v_lshl_add_u32 v6, v8, 4, v6
    s_lshl_b32 s15, s13, 9
    s_waitcnt vmcnt(56)
    v_lshl_or_b32 v16, v48, 16, v16
    v_lshl_or_b32 v17, v49, 16, v17
    v_lshl_or_b32 v18, v50, 16, v18
    v_lshl_or_b32 v19, v51, 16, v19
    ds_write_b128 v4, v[16:19] offset:0
    s_waitcnt vmcnt(48)
    v_lshl_or_b32 v20, v52, 16, v20
    v_lshl_or_b32 v21, v53, 16, v21
    v_lshl_or_b32 v22, v54, 16, v22
    v_lshl_or_b32 v23, v55, 16, v23
    ds_write_b128 v4, v[20:23] offset:16
    s_waitcnt vmcnt(40)
    v_lshl_or_b32 v24, v56, 16, v24
    v_lshl_or_b32 v25, v57, 16, v25
    v_lshl_or_b32 v26, v58, 16, v26
    v_lshl_or_b32 v27, v59, 16, v27
    ds_write_b128 v4, v[24:27] offset:32
    s_waitcnt vmcnt(32)
    v_lshl_or_b32 v28, v60, 16, v28
    v_lshl_or_b32 v29, v61, 16, v29
    v_lshl_or_b32 v30, v62, 16, v30
    v_lshl_or_b32 v31, v63, 16, v31
    ds_write_b128 v4, v[28:31] offset:48
    s_waitcnt vmcnt(24)
    v_lshl_or_b32 v32, v64, 16, v32
    v_lshl_or_b32 v33, v65, 16, v33
    v_lshl_or_b32 v34, v66, 16, v34
    v_lshl_or_b32 v35, v67, 16, v35
    ds_write_b128 v4, v[32:35] offset:64
    s_waitcnt vmcnt(16)
    v_lshl_or_b32 v36, v68, 16, v36
    v_lshl_or_b32 v37, v69, 16, v37
    v_lshl_or_b32 v38, v70, 16, v38
    v_lshl_or_b32 v39, v71, 16, v39
    ds_write_b128 v4, v[36:39] offset:80
    s_waitcnt vmcnt(8)
    v_lshl_or_b32 v40, v72, 16, v40
    v_lshl_or_b32 v41, v73, 16, v41
    v_lshl_or_b32 v42, v74, 16, v42
    v_lshl_or_b32 v43, v75, 16, v43
    ds_write_b128 v4, v[40:43] offset:96
    s_waitcnt vmcnt(0)
    v_lshl_or_b32 v44, v76, 16, v44
    v_lshl_or_b32 v45, v77, 16, v45
    v_lshl_or_b32 v46, v78, 16, v46
    v_lshl_or_b32 v47, v79, 16, v47
    ds_write_b128 v4, v[44:47] offset:112
    s_waitcnt lgkmcnt(0)
    s_barrier
    ds_read_b128 v[80:83], v5 offset:0
    ds_read_b128 v[84:87], v5 offset:4224
    ds_read_b128 v[88:91], v5 offset:8448
    ds_read_b128 v[92:95], v5 offset:12672
    ds_read_b128 v[96:99], v5 offset:16896
    ds_read_b128 v[100:103], v5 offset:21120
    ds_read_b128 v[104:107], v5 offset:25344
    s_waitcnt lgkmcnt(6)
    buffer_store_dwordx4 v[80:83], v6, s[24:27], s15 offen sc0 sc1
    s_add_u32 s15, s15, 0x10000
    s_waitcnt lgkmcnt(5)
    buffer_store_dwordx4 v[84:87], v6, s[24:27], s15 offen sc0 sc1
    s_add_u32 s15, s15, 0x10000
    s_waitcnt lgkmcnt(4)
    buffer_store_dwordx4 v[88:91], v6, s[24:27], s15 offen sc0 sc1
    s_add_u32 s15, s15, 0x10000
    s_waitcnt lgkmcnt(3)
    buffer_store_dwordx4 v[92:95], v6, s[24:27], s15 offen sc0 sc1
    s_add_u32 s15, s15, 0x10000
    s_waitcnt lgkmcnt(2)
    buffer_store_dwordx4 v[96:99], v6, s[24:27], s15 offen sc0 sc1
    s_add_u32 s15, s15, 0x10000
    s_waitcnt lgkmcnt(1)
    buffer_store_dwordx4 v[100:103], v6, s[24:27], s15 offen sc0 sc1
    s_add_u32 s15, s15, 0x10000
    s_waitcnt lgkmcnt(0)
    buffer_store_dwordx4 v[104:107], v6, s[24:27], s15 offen sc0 sc1
    s_endpgm
K1_PF:
    s_load_dwordx2 s[24:25], s[0:1], 32
    s_load_dwordx2 s[26:27], s[0:1], 48
    s_load_dwordx2 s[28:29], s[0:1], 40
    s_load_dwordx2 s[30:31], s[0:1], 56
    s_sub_u32 s12, s2, 352
    s_lshl_b32 s12, s12, 2
    s_add_u32 s12, s12, s3
    s_mul_i32 s12, s12, 6144
    v_lshlrev_b32 v3, 4, v2
    s_waitcnt lgkmcnt(0)
    s_getpc_b64 s[46:47]
CPF2:
    s_add_u32 s46, s46, k2_kernel-CPF2
    s_addc_u32 s47, s47, (k2_kernel-CPF2)>>32
    v_lshlrev_b32 v8, 6, v0
    v_add_u32 v8, 0, v8
    v_min_u32 v8, K3_END-k2_kernel-4, v8
    v_mov_b32 v9, s47
    v_add_co_u32 v8, vcc, s46, v8
    v_addc_co_u32 v9, vcc, 0, v9, vcc
    global_load_dword v10, v[8:9], off
    v_lshlrev_b32 v8, 6, v0
    v_add_u32 v8, 16384, v8
    v_min_u32 v8, K3_END-k2_kernel-4, v8
    v_mov_b32 v9, s47
    v_add_co_u32 v8, vcc, s46, v8
    v_addc_co_u32 v9, vcc, 0, v9, vcc
    global_load_dword v11, v[8:9], off
    s_mov_b32 s16, s24
    s_mov_b32 s17, s25
    s_mov_b32 s18, 0x21c000
    s_mov_b32 s19, 0x00020000
    s_mov_b32 s20, s26
    s_mov_b32 s21, s27
    s_mov_b32 s22, 0x21c000
    s_mov_b32 s23, 0x00020000
    s_mov_b32 s32, s28
    s_mov_b32 s33, s29
    s_mov_b32 s34, 0xd80
    s_mov_b32 s35, 0x00020000
    s_mov_b32 s36, s30
    s_mov_b32 s37, s31
    s_mov_b32 s38, 0x500
    s_mov_b32 s39, 0x00020000
    v_lshlrev_b32 v4, 4, v0
    buffer_load_dwordx4 v[240:243], v4, s[32:35], 0 offen
    buffer_load_dwordx4 v[244:247], v4, s[36:39], 0 offen
    buffer_load_dwordx4 v[16:19], v3, s[16:19], s12 offen
    s_add_u32 s12, s12, 1024
    buffer_load_dwordx4 v[20:23], v3, s[16:19], s12 offen
    s_add_u32 s12, s12, 1024
    buffer_load_dwordx4 v[24:27], v3, s[16:19], s12 offen
    s_add_u32 s12, s12, 1024
    buffer_load_dwordx4 v[28:31], v3, s[16:19], s12 offen
    s_add_u32 s12, s12, 1024
    buffer_load_dwordx4 v[32:35], v3, s[16:19], s12 offen
    s_add_u32 s12, s12, 1024
    buffer_load_dwordx4 v[36:39], v3, s[16:19], s12 offen
    s_add_u32 s12, s12, 1024
    s_waitcnt vmcnt(0)
    s_endpgm
K1_END:
    s_endpgm
.globl k2_kernel
.p2align 8
.type k2_kernel,@function
k2_kernel:
    s_cmp_ge_u32 s2, 252
    s_cbranch_scc1 K2_END
    s_load_dwordx4 s[4:7], s[0:1], 32
    s_load_dwordx2 s[8:9], s[0:1], 48
    s_load_dwordx2 s[10:11], s[0:1], 80
    v_lshrrev_b32 v1, 6, v0
    v_and_b32 v2, 63, v0
    v_readfirstlane_b32 s3, v1
    s_cmp_ge_u32 s2, 225
    s_cbranch_scc1 K2_SIDE
    s_cmp_ge_u32 s2, 144
    s_cbranch_scc1 K2_FFT
    s_and_b32 s12, s2, 1
    s_mul_i32 s12, s12, 18
    s_lshr_b32 s13, s2, 3
    s_add_u32 s13, s13, s12
    s_and_b32 s14, s13, 3
    s_lshr_b32 s13, s13, 2
    s_and_b32 s12, s2, 6
    s_lshl_b32 s12, s12, 1
    s_add_u32 s12, s12, s14
    s_and_b32 s14, s3, 1
    s_lshr_b32 s15, s3, 1
    v_lshrrev_b32 v3, 3, v2
    v_and_b32 v4, 7, v2
    v_lshlrev_b32 v5, 1, v3
    v_and_b32 v5, 4, v5
    v_xor_b32 v4, v4, v5
    v_mul_u32_u24 v3, 3456, v3
    v_lshl_add_u32 v3, v4, 4, v3
    v_lshlrev_b32 v4, 4, v2
    v_lshrrev_b32 v5, 5, v2
    v_lshlrev_b32 v6, 3, v5
    s_mul_i32 s32, s3, 55296
    s_mul_i32 s33, s13, 384
    s_add_u32 s32, s32, s33
    s_lshl_b32 s34, s12, 2
    s_add_u32 s34, s34, s3
    s_mul_i32 s34, s34, 40960
    s_mul_i32 s35, s14, 192
    s_add_u32 s35, s35, s33
    s_lshl_b32 s36, s3, 11
    s_lshl_b32 s37, s3, 12
    s_add_u32 s37, s37, 24576
    s_waitcnt lgkmcnt(0)
    s_mov_b32 s16, s4
    s_mov_b32 s17, s5
    s_mov_b32 s18, 0x21c000
    s_mov_b32 s19, 0x00020000
    s_add_u32 s20, s10, 0x600000
    s_addc_u32 s21, s11, 0
    s_mov_b32 s22, 0x280000
    s_mov_b32 s23, 0x00020000
    s_mov_b32 s24, s6
    s_mov_b32 s25, s7
    s_mov_b32 s26, 0xd80
    s_mov_b32 s27, 0x00020000
    s_add_u32 s28, s10, 0x900000
    s_addc_u32 s29, s11, 0
    s_mov_b32 s30, 0x960000
    s_mov_b32 s31, 0x00020000
    s_add_u32 m0, s36, 0
    s_add_u32 s38, s32, 0
    buffer_load_dwordx4 v3, s[16:19], s38 offen lds
    s_add_u32 m0, s36, 1024
    s_add_u32 s38, s32, 27648
    buffer_load_dwordx4 v3, s[16:19], s38 offen lds
    s_add_u32 m0, s36, 8192
    s_add_u32 s38, s32, 128
    buffer_load_dwordx4 v3, s[16:19], s38 offen lds
    s_add_u32 m0, s36, 9216
    s_add_u32 s38, s32, 27776
    buffer_load_dwordx4 v3, s[16:19], s38 offen lds
    s_add_u32 m0, s36, 16384
    s_add_u32 s38, s32, 256
    buffer_load_dwordx4 v3, s[16:19], s38 offen lds
    s_add_u32 m0, s36, 17408
    s_add_u32 s38, s32, 27904
    buffer_load_dwordx4 v3, s[16:19], s38 offen lds
    s_add_u32 m0, s37, 0
    s_add_u32 s38, s34, 0
    buffer_load_dwordx4 v4, s[20:23], s38 offen lds
    buffer_load_dwordx4 v4, s[20:23], s38 offen offset:1024 lds
    buffer_load_dwordx4 v4, s[20:23], s38 offen offset:2048 lds
    buffer_load_dwordx4 v4, s[20:23], s38 offen offset:3072 lds
    buffer_load_dwordx2 v[160:161], v6, s[24:27], s35 offen offset:0
    buffer_load_dwordx2 v[162:163], v6, s[24:27], s35 offen offset:16
    buffer_load_dwordx2 v[164:165], v6, s[24:27], s35 offen offset:32
    buffer_load_dwordx2 v[166:167], v6, s[24:27], s35 offen offset:48
    buffer_load_dwordx2 v[168:169], v6, s[24:27], s35 offen offset:64
    buffer_load_dwordx2 v[170:171], v6, s[24:27], s35 offen offset:80
    buffer_load_dwordx2 v[172:173], v6, s[24:27], s35 offen offset:96
    buffer_load_dwordx2 v[174:175], v6, s[24:27], s35 offen offset:112
    buffer_load_dwordx2 v[176:177], v6, s[24:27], s35 offen offset:128
    buffer_load_dwordx2 v[178:179], v6, s[24:27], s35 offen offset:144
    buffer_load_dwordx2 v[180:181], v6, s[24:27], s35 offen offset:160
    buffer_load_dwordx2 v[182:183], v6, s[24:27], s35 offen offset:176
    s_add_u32 m0, s36, 40960
    s_add_u32 s38, s32, 221184
    buffer_load_dwordx4 v3, s[16:19], s38 offen lds
    s_add_u32 m0, s36, 41984
    s_add_u32 s38, s32, 248832
    buffer_load_dwordx4 v3, s[16:19], s38 offen lds
    s_add_u32 m0, s36, 49152
    s_add_u32 s38, s32, 221312
    buffer_load_dwordx4 v3, s[16:19], s38 offen lds
    s_add_u32 m0, s36, 50176
    s_add_u32 s38, s32, 248960
    buffer_load_dwordx4 v3, s[16:19], s38 offen lds
    s_add_u32 m0, s36, 57344
    s_add_u32 s38, s32, 221440
    buffer_load_dwordx4 v3, s[16:19], s38 offen lds
    s_add_u32 m0, s36, 58368
    s_add_u32 s38, s32, 249088
    buffer_load_dwordx4 v3, s[16:19], s38 offen lds
    s_add_u32 m0, s37, 40960
    s_add_u32 s38, s34, 4096
    buffer_load_dwordx4 v4, s[20:23], s38 offen lds
    buffer_load_dwordx4 v4, s[20:23], s38 offen offset:1024 lds
    buffer_load_dwordx4 v4, s[20:23], s38 offen offset:2048 lds
    buffer_load_dwordx4 v4, s[20:23], s38 offen offset:3072 lds
    s_getpc_b64 s[46:47]
CPF3:
    s_add_u32 s46, s46, k2_kernel-CPF3
    s_addc_u32 s47, s47, (k2_kernel-CPF3)>>32
    v_lshlrev_b32 v240, 6, v0
    v_add_u32 v240, 0, v240
    v_min_u32 v240, K2_FFT-k2_kernel-4, v240
    v_mov_b32 v241, s47
    v_add_co_u32 v240, vcc, s46, v240
    v_addc_co_u32 v241, vcc, 0, v241, vcc
    global_load_dword v242, v[240:241], off
    v_bfe_u32 v7, v2, 2, 2
    v_and_b32 v8, 3, v2
    v_bfe_u32 v9, v2, 4, 1
    v_lshlrev_b32 v10, 10, v5
    v_lshl_add_u32 v10, v7, 7, v10
    v_lshl_add_u32 v10, v9, 5, v10
    v_lshl_add_u32 v10, v8, 3, v10
    v_lshrrev_b32 v7, 1, v7
    v_xor_b32 v7, s14, v7
    v_lshl_add_u32 v11, v7, 6, v10
    v_xor_b32 v12, 64, v11
    s_lshl_b32 s39, s14, 13
    s_lshl_b32 s40, s15, 13
    s_add_u32 s40, s40, 24576
    s_add_u32 s41, s39, 0
    v_add_u32 v16, s41, v11
    s_add_u32 s41, s41, s39
    v_add_u32 v17, s41, v12
    s_add_u32 s41, s40, 0
    v_add_u32 v18, s41, v4
    s_add_u32 s41, s39, 40960
    v_add_u32 v20, s41, v11
    s_add_u32 s41, s41, s39
    v_add_u32 v21, s41, v12
    s_add_u32 s41, s40, 40960
    v_add_u32 v22, s41, v4
    s_add_u32 s41, s39, 81920
    v_add_u32 v24, s41, v11
    s_add_u32 s41, s41, s39
    v_add_u32 v25, s41, v12
    s_add_u32 s41, s40, 81920
    v_add_u32 v26, s41, v4
    s_add_u32 s41, s39, 122880
    v_add_u32 v28, s41, v11
    s_add_u32 s41, s41, s39
    v_add_u32 v29, s41, v12
    s_add_u32 s41, s40, 122880
    v_add_u32 v30, s41, v4
    s_waitcnt vmcnt(11)
    v_lshlrev_b32 v32, 16, v160
    v_and_b32 v33, 0xffff0000, v160
    v_lshlrev_b32 v48, 16, v160
    v_and_b32 v49, 0xffff0000, v160
    v_lshlrev_b32 v34, 16, v161
    v_and_b32 v35, 0xffff0000, v161
    v_lshlrev_b32 v50, 16, v161
    v_and_b32 v51, 0xffff0000, v161
    v_lshlrev_b32 v36, 16, v162
    v_and_b32 v37, 0xffff0000, v162
    v_lshlrev_b32 v52, 16, v162
    v_and_b32 v53, 0xffff0000, v162
    v_lshlrev_b32 v38, 16, v163
    v_and_b32 v39, 0xffff0000, v163
    v_lshlrev_b32 v54, 16, v163
    v_and_b32 v55, 0xffff0000, v163
    v_lshlrev_b32 v40, 16, v164
    v_and_b32 v41, 0xffff0000, v164
    v_lshlrev_b32 v56, 16, v164
    v_and_b32 v57, 0xffff0000, v164
    v_lshlrev_b32 v42, 16, v165
    v_and_b32 v43, 0xffff0000, v165
    v_lshlrev_b32 v58, 16, v165
    v_and_b32 v59, 0xffff0000, v165
    v_lshlrev_b32 v44, 16, v166
    v_and_b32 v45, 0xffff0000, v166
    v_lshlrev_b32 v60, 16, v166
    v_and_b32 v61, 0xffff0000, v166
    v_lshlrev_b32 v46, 16, v167
    v_and_b32 v47, 0xffff0000, v167
    v_lshlrev_b32 v62, 16, v167
    v_and_b32 v63, 0xffff0000, v167
    v_lshlrev_b32 v64, 16, v168
    v_and_b32 v65, 0xffff0000, v168
    v_lshlrev_b32 v80, 16, v168
    v_and_b32 v81, 0xffff0000, v168
    v_lshlrev_b32 v66, 16, v169
    v_and_b32 v67, 0xffff0000, v169
    v_lshlrev_b32 v82, 16, v169
    v_and_b32 v83, 0xffff0000, v169
    v_lshlrev_b32 v68, 16, v170
    v_and_b32 v69, 0xffff0000, v170
    v_lshlrev_b32 v84, 16, v170
    v_and_b32 v85, 0xffff0000, v170
    v_lshlrev_b32 v70, 16, v171
    v_and_b32 v71, 0xffff0000, v171
    v_lshlrev_b32 v86, 16, v171
    v_and_b32 v87, 0xffff0000, v171
    v_lshlrev_b32 v72, 16, v172
    v_and_b32 v73, 0xffff0000, v172
    v_lshlrev_b32 v88, 16, v172
    v_and_b32 v89, 0xffff0000, v172
    v_lshlrev_b32 v74, 16, v173
    v_and_b32 v75, 0xffff0000, v173
    v_lshlrev_b32 v90, 16, v173
    v_and_b32 v91, 0xffff0000, v173
    v_lshlrev_b32 v76, 16, v174
    v_and_b32 v77, 0xffff0000, v174
    v_lshlrev_b32 v92, 16, v174
    v_and_b32 v93, 0xffff0000, v174
    v_lshlrev_b32 v78, 16, v175
    v_and_b32 v79, 0xffff0000, v175
    v_lshlrev_b32 v94, 16, v175
    v_and_b32 v95, 0xffff0000, v175
    v_lshlrev_b32 v96, 16, v176
    v_and_b32 v97, 0xffff0000, v176
    v_lshlrev_b32 v112, 16, v176
    v_and_b32 v113, 0xffff0000, v176
    v_lshlrev_b32 v98, 16, v177
    v_and_b32 v99, 0xffff0000, v177
    v_lshlrev_b32 v114, 16, v177
    v_and_b32 v115, 0xffff0000, v177
    v_lshlrev_b32 v100, 16, v178
    v_and_b32 v101, 0xffff0000, v178
    v_lshlrev_b32 v116, 16, v178
    v_and_b32 v117, 0xffff0000, v178
    v_lshlrev_b32 v102, 16, v179
    v_and_b32 v103, 0xffff0000, v179
    v_lshlrev_b32 v118, 16, v179
    v_and_b32 v119, 0xffff0000, v179
    v_lshlrev_b32 v104, 16, v180
    v_and_b32 v105, 0xffff0000, v180
    v_lshlrev_b32 v120, 16, v180
    v_and_b32 v121, 0xffff0000, v180
    v_lshlrev_b32 v106, 16, v181
    v_and_b32 v107, 0xffff0000, v181
    v_lshlrev_b32 v122, 16, v181
    v_and_b32 v123, 0xffff0000, v181
    v_lshlrev_b32 v108, 16, v182
    v_and_b32 v109, 0xffff0000, v182
    v_lshlrev_b32 v124, 16, v182
    v_and_b32 v125, 0xffff0000, v182
    v_lshlrev_b32 v110, 16, v183
    v_and_b32 v111, 0xffff0000, v183
    v_lshlrev_b32 v126, 16, v183
    v_and_b32 v127, 0xffff0000, v183
    s_waitcnt vmcnt(11)
    s_barrier
    ds_read_b128 v[204:207], v18 offset:0
    ds_read_b128 v[208:211], v18 offset:4096
    ds_read_b64_tr_b16 v[192:193], v16 offset:0
    ds_read_b64_tr_b16 v[194:195], v16 offset:512
    ds_read_b64_tr_b16 v[196:197], v17 offset:0
    ds_read_b64_tr_b16 v[198:199], v17 offset:512
    ds_read_b64_tr_b16 v[200:201], v16 offset:8192
    ds_read_b64_tr_b16 v[202:203], v16 offset:8704
    s_waitcnt lgkmcnt(0)
    v_mfma_f32_32x32x16_bf16 v[32:47], v[192:195], v[204:207], v[32:47]
    ds_read_b128 v[224:227], v18 offset:1024
    ds_read_b128 v[228:231], v18 offset:5120
    ds_read_b64_tr_b16 v[212:213], v16 offset:2048
    s_add_u32 m0, s36, 81920
    s_add_u32 s38, s32, 442368
    buffer_load_dwordx4 v3, s[16:19], s38 offen lds
    v_mfma_f32_32x32x16_bf16 v[48:63], v[192:195], v[208:211], v[48:63]
    ds_read_b64_tr_b16 v[214:215], v16 offset:2560
    ds_read_b64_tr_b16 v[216:217], v17 offset:2048
    ds_read_b64_tr_b16 v[218:219], v17 offset:2560
    s_add_u32 m0, s36, 82944
    s_add_u32 s38, s32, 470016
    buffer_load_dwordx4 v3, s[16:19], s38 offen lds
    v_mfma_f32_32x32x16_bf16 v[64:79], v[196:199], v[204:207], v[64:79]
    ds_read_b64_tr_b16 v[220:221], v16 offset:10240
    ds_read_b64_tr_b16 v[222:223], v16 offset:10752
    v_mfma_f32_32x32x16_bf16 v[80:95], v[196:199], v[208:211], v[80:95]
    s_add_u32 m0, s36, 90112
    s_add_u32 s38, s32, 442496
    buffer_load_dwordx4 v3, s[16:19], s38 offen lds
    v_mfma_f32_32x32x16_bf16 v[96:111], v[200:203], v[204:207], v[96:111]
    s_add_u32 m0, s36, 91136
    s_add_u32 s38, s32, 470144
    buffer_load_dwordx4 v3, s[16:19], s38 offen lds
    v_mfma_f32_32x32x16_bf16 v[112:127], v[200:203], v[208:211], v[112:127]
    s_waitcnt lgkmcnt(0)
    v_mfma_f32_32x32x16_bf16 v[32:47], v[212:215], v[224:227], v[32:47]
    ds_read_b128 v[204:207], v18 offset:2048
    ds_read_b128 v[208:211], v18 offset:6144
    ds_read_b64_tr_b16 v[192:193], v16 offset:4096
    s_add_u32 m0, s36, 98304
    s_add_u32 s38, s32, 442624
    buffer_load_dwordx4 v3, s[16:19], s38 offen lds
    v_mfma_f32_32x32x16_bf16 v[48:63], v[212:215], v[228:231], v[48:63]
    ds_read_b64_tr_b16 v[194:195], v16 offset:4608
    ds_read_b64_tr_b16 v[196:197], v17 offset:4096
    ds_read_b64_tr_b16 v[198:199], v17 offset:4608
    s_add_u32 m0, s36, 99328
    s_add_u32 s38, s32, 470272
    buffer_load_dwordx4 v3, s[16:19], s38 offen lds
    v_mfma_f32_32x32x16_bf16 v[64:79], v[216:219], v[224:227], v[64:79]
    ds_read_b64_tr_b16 v[200:201], v16 offset:12288
    ds_read_b64_tr_b16 v[202:203], v16 offset:12800
    v_mfma_f32_32x32x16_bf16 v[80:95], v[216:219], v[228:231], v[80:95]
    s_add_u32 m0, s37, 81920
    s_add_u32 s38, s34, 8192
    buffer_load_dwordx4 v4, s[20:23], s38 offen lds
    v_mfma_f32_32x32x16_bf16 v[96:111], v[220:223], v[224:227], v[96:111]
    buffer_load_dwordx4 v4, s[20:23], s38 offen offset:1024 lds
    v_mfma_f32_32x32x16_bf16 v[112:127], v[220:223], v[228:231], v[112:127]
    s_waitcnt lgkmcnt(0)
    v_mfma_f32_32x32x16_bf16 v[32:47], v[192:195], v[204:207], v[32:47]
    ds_read_b128 v[224:227], v18 offset:3072
    ds_read_b128 v[228:231], v18 offset:7168
    ds_read_b64_tr_b16 v[212:213], v16 offset:6144
    buffer_load_dwordx4 v4, s[20:23], s38 offen offset:2048 lds
    v_mfma_f32_32x32x16_bf16 v[48:63], v[192:195], v[208:211], v[48:63]
    ds_read_b64_tr_b16 v[214:215], v16 offset:6656
    ds_read_b64_tr_b16 v[216:217], v17 offset:6144
    ds_read_b64_tr_b16 v[218:219], v17 offset:6656
    buffer_load_dwordx4 v4, s[20:23], s38 offen offset:3072 lds
    v_mfma_f32_32x32x16_bf16 v[64:79], v[196:199], v[204:207], v[64:79]
    ds_read_b64_tr_b16 v[220:221], v16 offset:14336
    ds_read_b64_tr_b16 v[222:223], v16 offset:14848
    v_mfma_f32_32x32x16_bf16 v[80:95], v[196:199], v[208:211], v[80:95]
    s_add_u32 m0, s36, 122880
    s_add_u32 s38, s32, 663552
    buffer_load_dwordx4 v3, s[16:19], s38 offen lds
    v_mfma_f32_32x32x16_bf16 v[96:111], v[200:203], v[204:207], v[96:111]
    s_add_u32 m0, s36, 123904
    s_add_u32 s38, s32, 691200
    buffer_load_dwordx4 v3, s[16:19], s38 offen lds
    v_mfma_f32_32x32x16_bf16 v[112:127], v[200:203], v[208:211], v[112:127]
    s_waitcnt lgkmcnt(0) vmcnt(13)
    s_barrier
    ds_read_b128 v[204:207], v22 offset:0
    ds_read_b128 v[208:211], v22 offset:4096
    ds_read_b64_tr_b16 v[192:193], v20 offset:0
    v_mfma_f32_32x32x16_bf16 v[32:47], v[212:215], v[224:227], v[32:47]
    ds_read_b64_tr_b16 v[194:195], v20 offset:512
    ds_read_b64_tr_b16 v[196:197], v21 offset:0
    ds_read_b64_tr_b16 v[198:199], v21 offset:512
    s_add_u32 m0, s36, 131072
    s_add_u32 s38, s32, 663680
    buffer_load_dwordx4 v3, s[16:19], s38 offen lds
    v_mfma_f32_32x32x16_bf16 v[48:63], v[212:215], v[228:231], v[48:63]
    ds_read_b64_tr_b16 v[200:201], v20 offset:8192
    ds_read_b64_tr_b16 v[202:203], v20 offset:8704
    s_add_u32 m0, s36, 132096
    s_add_u32 s38, s32, 691328
    buffer_load_dwordx4 v3, s[16:19], s38 offen lds
    v_mfma_f32_32x32x16_bf16 v[64:79], v[216:219], v[224:227], v[64:79]
    v_mfma_f32_32x32x16_bf16 v[80:95], v[216:219], v[228:231], v[80:95]
    s_add_u32 m0, s36, 139264
    s_add_u32 s38, s32, 663808
    buffer_load_dwordx4 v3, s[16:19], s38 offen lds
    v_mfma_f32_32x32x16_bf16 v[96:111], v[220:223], v[224:227], v[96:111]
    s_add_u32 m0, s36, 140288
    s_add_u32 s38, s32, 691456
    buffer_load_dwordx4 v3, s[16:19], s38 offen lds
    v_mfma_f32_32x32x16_bf16 v[112:127], v[220:223], v[228:231], v[112:127]
    s_waitcnt lgkmcnt(0)
    v_mfma_f32_32x32x16_bf16 v[32:47], v[192:195], v[204:207], v[32:47]
    ds_read_b128 v[224:227], v22 offset:1024
    ds_read_b128 v[228:231], v22 offset:5120
    ds_read_b64_tr_b16 v[212:213], v20 offset:2048
    s_add_u32 m0, s37, 122880
    s_add_u32 s38, s34, 12288
    buffer_load_dwordx4 v4, s[20:23], s38 offen lds
    v_mfma_f32_32x32x16_bf16 v[48:63], v[192:195], v[208:211], v[48:63]
    ds_read_b64_tr_b16 v[214:215], v20 offset:2560
    ds_read_b64_tr_b16 v[216:217], v21 offset:2048
    ds_read_b64_tr_b16 v[218:219], v21 offset:2560
    v_mfma_f32_32x32x16_bf16 v[64:79], v[196:199], v[204:207], v[64:79]
    ds_read_b64_tr_b16 v[220:221], v20 offset:10240
    ds_read_b64_tr_b16 v[222:223], v20 offset:10752
    buffer_load_dwordx4 v4, s[20:23], s38 offen offset:1024 lds
    v_mfma_f32_32x32x16_bf16 v[80:95], v[196:199], v[208:211], v[80:95]
    v_mfma_f32_32x32x16_bf16 v[96:111], v[200:203], v[204:207], v[96:111]
    buffer_load_dwordx4 v4, s[20:23], s38 offen offset:2048 lds
    v_mfma_f32_32x32x16_bf16 v[112:127], v[200:203], v[208:211], v[112:127]
    s_waitcnt lgkmcnt(0)
    v_mfma_f32_32x32x16_bf16 v[32:47], v[212:215], v[224:227], v[32:47]
    ds_read_b128 v[204:207], v22 offset:2048
    ds_read_b128 v[208:211], v22 offset:6144
    ds_read_b64_tr_b16 v[192:193], v20 offset:4096
    buffer_load_dwordx4 v4, s[20:23], s38 offen offset:3072 lds
    v_mfma_f32_32x32x16_bf16 v[48:63], v[212:215], v[228:231], v[48:63]
    ds_read_b64_tr_b16 v[194:195], v20 offset:4608
    ds_read_b64_tr_b16 v[196:197], v21 offset:4096
    ds_read_b64_tr_b16 v[198:199], v21 offset:4608
    v_mfma_f32_32x32x16_bf16 v[64:79], v[216:219], v[224:227], v[64:79]
    ds_read_b64_tr_b16 v[200:201], v20 offset:12288
    ds_read_b64_tr_b16 v[202:203], v20 offset:12800
    s_add_u32 m0, s36, 0
    s_add_u32 s38, s32, 884736
    buffer_load_dwordx4 v3, s[16:19], s38 offen lds
    v_mfma_f32_32x32x16_bf16 v[80:95], v[216:219], v[228:231], v[80:95]
    v_mfma_f32_32x32x16_bf16 v[96:111], v[220:223], v[224:227], v[96:111]
    s_add_u32 m0, s36, 1024
    s_add_u32 s38, s32, 912384
    buffer_load_dwordx4 v3, s[16:19], s38 offen lds
    v_mfma_f32_32x32x16_bf16 v[112:127], v[220:223], v[228:231], v[112:127]
    s_waitcnt lgkmcnt(0)
    v_mfma_f32_32x32x16_bf16 v[32:47], v[192:195], v[204:207], v[32:47]
    ds_read_b128 v[224:227], v22 offset:3072
    ds_read_b128 v[228:231], v22 offset:7168
    ds_read_b64_tr_b16 v[212:213], v20 offset:6144
    s_add_u32 m0, s36, 8192
    s_add_u32 s38, s32, 884864
    buffer_load_dwordx4 v3, s[16:19], s38 offen lds
    v_mfma_f32_32x32x16_bf16 v[48:63], v[192:195], v[208:211], v[48:63]
    ds_read_b64_tr_b16 v[214:215], v20 offset:6656
    ds_read_b64_tr_b16 v[216:217], v21 offset:6144
    ds_read_b64_tr_b16 v[218:219], v21 offset:6656
    v_mfma_f32_32x32x16_bf16 v[64:79], v[196:199], v[204:207], v[64:79]
    ds_read_b64_tr_b16 v[220:221], v20 offset:14336
    ds_read_b64_tr_b16 v[222:223], v20 offset:14848
    s_add_u32 m0, s36, 9216
    s_add_u32 s38, s32, 912512
    buffer_load_dwordx4 v3, s[16:19], s38 offen lds
    v_mfma_f32_32x32x16_bf16 v[80:95], v[196:199], v[208:211], v[80:95]
    v_mfma_f32_32x32x16_bf16 v[96:111], v[200:203], v[204:207], v[96:111]
    s_add_u32 m0, s36, 16384
    s_add_u32 s38, s32, 884992
    buffer_load_dwordx4 v3, s[16:19], s38 offen lds
    v_mfma_f32_32x32x16_bf16 v[112:127], v[200:203], v[208:211], v[112:127]
    s_waitcnt lgkmcnt(0) vmcnt(15)
    s_barrier
    ds_read_b128 v[204:207], v26 offset:0
    ds_read_b128 v[208:211], v26 offset:4096
    ds_read_b64_tr_b16 v[192:193], v24 offset:0
    v_mfma_f32_32x32x16_bf16 v[32:47], v[212:215], v[224:227], v[32:47]
    ds_read_b64_tr_b16 v[194:195], v24 offset:512
    ds_read_b64_tr_b16 v[196:197], v25 offset:0
    ds_read_b64_tr_b16 v[198:199], v25 offset:512
    s_add_u32 m0, s36, 17408
    s_add_u32 s38, s32, 912640
    buffer_load_dwordx4 v3, s[16:19], s38 offen lds
    v_mfma_f32_32x32x16_bf16 v[48:63], v[212:215], v[228:231], v[48:63]
    ds_read_b64_tr_b16 v[200:201], v24 offset:8192
    ds_read_b64_tr_b16 v[202:203], v24 offset:8704
    v_mfma_f32_32x32x16_bf16 v[64:79], v[216:219], v[224:227], v[64:79]
    s_add_u32 m0, s37, 0
    s_add_u32 s38, s34, 16384
    buffer_load_dwordx4 v4, s[20:23], s38 offen lds
    v_mfma_f32_32x32x16_bf16 v[80:95], v[216:219], v[228:231], v[80:95]
    v_mfma_f32_32x32x16_bf16 v[96:111], v[220:223], v[224:227], v[96:111]
    buffer_load_dwordx4 v4, s[20:23], s38 offen offset:1024 lds
    v_mfma_f32_32x32x16_bf16 v[112:127], v[220:223], v[228:231], v[112:127]
    s_waitcnt lgkmcnt(0)
    v_mfma_f32_32x32x16_bf16 v[32:47], v[192:195], v[204:207], v[32:47]
    ds_read_b128 v[224:227], v26 offset:1024
    ds_read_b128 v[228:231], v26 offset:5120
    ds_read_b64_tr_b16 v[212:213], v24 offset:2048
    buffer_load_dwordx4 v4, s[20:23], s38 offen offset:2048 lds
    v_mfma_f32_32x32x16_bf16 v[48:63], v[192:195], v[208:211], v[48:63]
    ds_read_b64_tr_b16 v[214:215], v24 offset:2560
    ds_read_b64_tr_b16 v[216:217], v25 offset:2048
    ds_read_b64_tr_b16 v[218:219], v25 offset:2560
    v_mfma_f32_32x32x16_bf16 v[64:79], v[196:199], v[204:207], v[64:79]
    ds_read_b64_tr_b16 v[220:221], v24 offset:10240
    ds_read_b64_tr_b16 v[222:223], v24 offset:10752
    buffer_load_dwordx4 v4, s[20:23], s38 offen offset:3072 lds
    v_mfma_f32_32x32x16_bf16 v[80:95], v[196:199], v[208:211], v[80:95]
    v_mfma_f32_32x32x16_bf16 v[96:111], v[200:203], v[204:207], v[96:111]
    s_add_u32 m0, s36, 40960
    s_add_u32 s38, s32, 1105920
    buffer_load_dwordx4 v3, s[16:19], s38 offen lds
    v_mfma_f32_32x32x16_bf16 v[112:127], v[200:203], v[208:211], v[112:127]
    s_waitcnt lgkmcnt(0)
    v_mfma_f32_32x32x16_bf16 v[32:47], v[212:215], v[224:227], v[32:47]
    ds_read_b128 v[204:207], v26 offset:2048
    ds_read_b128 v[208:211], v26 offset:6144
    ds_read_b64_tr_b16 v[192:193], v24 offset:4096
    s_add_u32 m0, s36, 41984
    s_add_u32 s38, s32, 1133568
    buffer_load_dwordx4 v3, s[16:19], s38 offen lds
    v_mfma_f32_32x32x16_bf16 v[48:63], v[212:215], v[228:231], v[48:63]
    ds_read_b64_tr_b16 v[194:195], v24 offset:4608
    ds_read_b64_tr_b16 v[196:197], v25 offset:4096
    ds_read_b64_tr_b16 v[198:199], v25 offset:4608
    v_mfma_f32_32x32x16_bf16 v[64:79], v[216:219], v[224:227], v[64:79]
    ds_read_b64_tr_b16 v[200:201], v24 offset:12288
    ds_read_b64_tr_b16 v[202:203], v24 offset:12800
    s_add_u32 m0, s36, 49152
    s_add_u32 s38, s32, 1106048
    buffer_load_dwordx4 v3, s[16:19], s38 offen lds
    v_mfma_f32_32x32x16_bf16 v[80:95], v[216:219], v[228:231], v[80:95]
    v_mfma_f32_32x32x16_bf16 v[96:111], v[220:223], v[224:227], v[96:111]
    s_add_u32 m0, s36, 50176
    s_add_u32 s38, s32, 1133696
    buffer_load_dwordx4 v3, s[16:19], s38 offen lds
    v_mfma_f32_32x32x16_bf16 v[112:127], v[220:223], v[228:231], v[112:127]
    s_waitcnt lgkmcnt(0)
    v_mfma_f32_32x32x16_bf16 v[32:47], v[192:195], v[204:207], v[32:47]
    ds_read_b128 v[224:227], v26 offset:3072
    ds_read_b128 v[228:231], v26 offset:7168
    ds_read_b64_tr_b16 v[212:213], v24 offset:6144
    s_add_u32 m0, s36, 57344
    s_add_u32 s38, s32, 1106176
    buffer_load_dwordx4 v3, s[16:19], s38 offen lds
    v_mfma_f32_32x32x16_bf16 v[48:63], v[192:195], v[208:211], v[48:63]
    ds_read_b64_tr_b16 v[214:215], v24 offset:6656
    ds_read_b64_tr_b16 v[216:217], v25 offset:6144
    ds_read_b64_tr_b16 v[218:219], v25 offset:6656
    v_mfma_f32_32x32x16_bf16 v[64:79], v[196:199], v[204:207], v[64:79]
    ds_read_b64_tr_b16 v[220:221], v24 offset:14336
    ds_read_b64_tr_b16 v[222:223], v24 offset:14848
    s_add_u32 m0, s36, 58368
    s_add_u32 s38, s32, 1133824
    buffer_load_dwordx4 v3, s[16:19], s38 offen lds
    v_mfma_f32_32x32x16_bf16 v[80:95], v[196:199], v[208:211], v[80:95]
    v_mfma_f32_32x32x16_bf16 v[96:111], v[200:203], v[204:207], v[96:111]
    s_add_u32 m0, s37, 40960
    s_add_u32 s38, s34, 20480
    buffer_load_dwordx4 v4, s[20:23], s38 offen lds
    v_mfma_f32_32x32x16_bf16 v[112:127], v[200:203], v[208:211], v[112:127]
    s_waitcnt lgkmcnt(0) vmcnt(17)
    s_barrier
    ds_read_b128 v[204:207], v30 offset:0
    ds_read_b128 v[208:211], v30 offset:4096
    ds_read_b64_tr_b16 v[192:193], v28 offset:0
    v_mfma_f32_32x32x16_bf16 v[32:47], v[212:215], v[224:227], v[32:47]
    ds_read_b64_tr_b16 v[194:195], v28 offset:512
    ds_read_b64_tr_b16 v[196:197], v29 offset:0
    ds_read_b64_tr_b16 v[198:199], v29 offset:512
    buffer_load_dwordx4 v4, s[20:23], s38 offen offset:1024 lds
    v_mfma_f32_32x32x16_bf16 v[48:63], v[212:215], v[228:231], v[48:63]
    ds_read_b64_tr_b16 v[200:201], v28 offset:8192
    ds_read_b64_tr_b16 v[202:203], v28 offset:8704
    v_mfma_f32_32x32x16_bf16 v[64:79], v[216:219], v[224:227], v[64:79]
    buffer_load_dwordx4 v4, s[20:23], s38 offen offset:2048 lds
    v_mfma_f32_32x32x16_bf16 v[80:95], v[216:219], v[228:231], v[80:95]
    v_mfma_f32_32x32x16_bf16 v[96:111], v[220:223], v[224:227], v[96:111]
    buffer_load_dwordx4 v4, s[20:23], s38 offen offset:3072 lds
    v_mfma_f32_32x32x16_bf16 v[112:127], v[220:223], v[228:231], v[112:127]
    s_waitcnt lgkmcnt(0)
    v_mfma_f32_32x32x16_bf16 v[32:47], v[192:195], v[204:207], v[32:47]
    ds_read_b128 v[224:227], v30 offset:1024
    ds_read_b128 v[228:231], v30 offset:5120
    ds_read_b64_tr_b16 v[212:213], v28 offset:2048
    s_add_u32 m0, s36, 81920
    s_add_u32 s38, s32, 1327104
    buffer_load_dwordx4 v3, s[16:19], s38 offen lds
    v_mfma_f32_32x32x16_bf16 v[48:63], v[192:195], v[208:211], v[48:63]
    ds_read_b64_tr_b16 v[214:215], v28 offset:2560
    ds_read_b64_tr_b16 v[216:217], v29 offset:2048
    ds_read_b64_tr_b16 v[218:219], v29 offset:2560
    v_mfma_f32_32x32x16_bf16 v[64:79], v[196:199], v[204:207], v[64:79]
    ds_read_b64_tr_b16 v[220:221], v28 offset:10240
    ds_read_b64_tr_b16 v[222:223], v28 offset:10752
    s_add_u32 m0, s36, 82944
    s_add_u32 s38, s32, 1354752
    buffer_load_dwordx4 v3, s[16:19], s38 offen lds
    v_mfma_f32_32x32x16_bf16 v[80:95], v[196:199], v[208:211], v[80:95]
    v_mfma_f32_32x32x16_bf16 v[96:111], v[200:203], v[204:207], v[96:111]
    s_add_u32 m0, s36, 90112
    s_add_u32 s38, s32, 1327232
    buffer_load_dwordx4 v3, s[16:19], s38 offen lds
    v_mfma_f32_32x32x16_bf16 v[112:127], v[200:203], v[208:211], v[112:127]
    s_waitcnt lgkmcnt(0)
    v_mfma_f32_32x32x16_bf16 v[32:47], v[212:215], v[224:227], v[32:47]
    ds_read_b128 v[204:207], v30 offset:2048
    ds_read_b128 v[208:211], v30 offset:6144
    ds_read_b64_tr_b16 v[192:193], v28 offset:4096
    s_add_u32 m0, s36, 91136
    s_add_u32 s38, s32, 1354880
    buffer_load_dwordx4 v3, s[16:19], s38 offen lds
    v_mfma_f32_32x32x16_bf16 v[48:63], v[212:215], v[228:231], v[48:63]
    ds_read_b64_tr_b16 v[194:195], v28 offset:4608
    ds_read_b64_tr_b16 v[196:197], v29 offset:4096
    ds_read_b64_tr_b16 v[198:199], v29 offset:4608
    v_mfma_f32_32x32x16_bf16 v[64:79], v[216:219], v[224:227], v[64:79]
    ds_read_b64_tr_b16 v[200:201], v28 offset:12288
    ds_read_b64_tr_b16 v[202:203], v28 offset:12800
    s_add_u32 m0, s36, 98304
    s_add_u32 s38, s32, 1327360
    buffer_load_dwordx4 v3, s[16:19], s38 offen lds
    v_mfma_f32_32x32x16_bf16 v[80:95], v[216:219], v[228:231], v[80:95]
    v_mfma_f32_32x32x16_bf16 v[96:111], v[220:223], v[224:227], v[96:111]
    s_add_u32 m0, s36, 99328
    s_add_u32 s38, s32, 1355008
    buffer_load_dwordx4 v3, s[16:19], s38 offen lds
    v_mfma_f32_32x32x16_bf16 v[112:127], v[220:223], v[228:231], v[112:127]
    s_waitcnt lgkmcnt(0)
    v_mfma_f32_32x32x16_bf16 v[32:47], v[192:195], v[204:207], v[32:47]
    ds_read_b128 v[224:227], v30 offset:3072
    ds_read_b128 v[228:231], v30 offset:7168
    ds_read_b64_tr_b16 v[212:213], v28 offset:6144
    s_add_u32 m0, s37, 81920
    s_add_u32 s38, s34, 24576
    buffer_load_dwordx4 v4, s[20:23], s38 offen lds
    v_mfma_f32_32x32x16_bf16 v[48:63], v[192:195], v[208:211], v[48:63]
    ds_read_b64_tr_b16 v[214:215], v28 offset:6656
    ds_read_b64_tr_b16 v[216:217], v29 offset:6144
    ds_read_b64_tr_b16 v[218:219], v29 offset:6656
    v_mfma_f32_32x32x16_bf16 v[64:79], v[196:199], v[204:207], v[64:79]
    ds_read_b64_tr_b16 v[220:221], v28 offset:14336
    ds_read_b64_tr_b16 v[222:223], v28 offset:14848
    buffer_load_dwordx4 v4, s[20:23], s38 offen offset:1024 lds
    v_mfma_f32_32x32x16_bf16 v[80:95], v[196:199], v[208:211], v[80:95]
    v_mfma_f32_32x32x16_bf16 v[96:111], v[200:203], v[204:207], v[96:111]
    buffer_load_dwordx4 v4, s[20:23], s38 offen offset:2048 lds
    v_mfma_f32_32x32x16_bf16 v[112:127], v[200:203], v[208:211], v[112:127]
    s_waitcnt lgkmcnt(0) vmcnt(19)
    s_barrier
    ds_read_b128 v[204:207], v18 offset:0
    ds_read_b128 v[208:211], v18 offset:4096
    ds_read_b64_tr_b16 v[192:193], v16 offset:0
    v_mfma_f32_32x32x16_bf16 v[32:47], v[212:215], v[224:227], v[32:47]
    ds_read_b64_tr_b16 v[194:195], v16 offset:512
    ds_read_b64_tr_b16 v[196:197], v17 offset:0
    ds_read_b64_tr_b16 v[198:199], v17 offset:512
    buffer_load_dwordx4 v4, s[20:23], s38 offen offset:3072 lds
    v_mfma_f32_32x32x16_bf16 v[48:63], v[212:215], v[228:231], v[48:63]
    ds_read_b64_tr_b16 v[200:201], v16 offset:8192
    ds_read_b64_tr_b16 v[202:203], v16 offset:8704
    v_mfma_f32_32x32x16_bf16 v[64:79], v[216:219], v[224:227], v[64:79]
    s_add_u32 m0, s36, 122880
    s_add_u32 s38, s32, 1548288
    buffer_load_dwordx4 v3, s[16:19], s38 offen lds
    v_mfma_f32_32x32x16_bf16 v[80:95], v[216:219], v[228:231], v[80:95]
    v_mfma_f32_32x32x16_bf16 v[96:111], v[220:223], v[224:227], v[96:111]
    s_add_u32 m0, s36, 123904
    s_add_u32 s38, s32, 1575936
    buffer_load_dwordx4 v3, s[16:19], s38 offen lds
    v_mfma_f32_32x32x16_bf16 v[112:127], v[220:223], v[228:231], v[112:127]
    s_waitcnt lgkmcnt(0)
    v_mfma_f32_32x32x16_bf16 v[32:47], v[192:195], v[204:207], v[32:47]
    ds_read_b128 v[224:227], v18 offset:1024
    ds_read_b128 v[228:231], v18 offset:5120
    ds_read_b64_tr_b16 v[212:213], v16 offset:2048
    s_add_u32 m0, s36, 131072
    s_add_u32 s38, s32, 1548416
    buffer_load_dwordx4 v3, s[16:19], s38 offen lds
    v_mfma_f32_32x32x16_bf16 v[48:63], v[192:195], v[208:211], v[48:63]
    ds_read_b64_tr_b16 v[214:215], v16 offset:2560
    ds_read_b64_tr_b16 v[216:217], v17 offset:2048
    ds_read_b64_tr_b16 v[218:219], v17 offset:2560
    v_mfma_f32_32x32x16_bf16 v[64:79], v[196:199], v[204:207], v[64:79]
    ds_read_b64_tr_b16 v[220:221], v16 offset:10240
    ds_read_b64_tr_b16 v[222:223], v16 offset:10752
    s_add_u32 m0, s36, 132096
    s_add_u32 s38, s32, 1576064
    buffer_load_dwordx4 v3, s[16:19], s38 offen lds
    v_mfma_f32_32x32x16_bf16 v[80:95], v[196:199], v[208:211], v[80:95]
    v_mfma_f32_32x32x16_bf16 v[96:111], v[200:203], v[204:207], v[96:111]
    s_add_u32 m0, s36, 139264
    s_add_u32 s38, s32, 1548544
    buffer_load_dwordx4 v3, s[16:19], s38 offen lds
    v_mfma_f32_32x32x16_bf16 v[112:127], v[200:203], v[208:211], v[112:127]
    s_waitcnt lgkmcnt(0)
    v_mfma_f32_32x32x16_bf16 v[32:47], v[212:215], v[224:227], v[32:47]
    ds_read_b128 v[204:207], v18 offset:2048
    ds_read_b128 v[208:211], v18 offset:6144
    ds_read_b64_tr_b16 v[192:193], v16 offset:4096
    s_add_u32 m0, s36, 140288
    s_add_u32 s38, s32, 1576192
    buffer_load_dwordx4 v3, s[16:19], s38 offen lds
    v_mfma_f32_32x32x16_bf16 v[48:63], v[212:215], v[228:231], v[48:63]
    ds_read_b64_tr_b16 v[194:195], v16 offset:4608
    ds_read_b64_tr_b16 v[196:197], v17 offset:4096
    ds_read_b64_tr_b16 v[198:199], v17 offset:4608
    v_mfma_f32_32x32x16_bf16 v[64:79], v[216:219], v[224:227], v[64:79]
    ds_read_b64_tr_b16 v[200:201], v16 offset:12288
    ds_read_b64_tr_b16 v[202:203], v16 offset:12800
    s_add_u32 m0, s37, 122880
    s_add_u32 s38, s34, 28672
    buffer_load_dwordx4 v4, s[20:23], s38 offen lds
    v_mfma_f32_32x32x16_bf16 v[80:95], v[216:219], v[228:231], v[80:95]
    v_mfma_f32_32x32x16_bf16 v[96:111], v[220:223], v[224:227], v[96:111]
    buffer_load_dwordx4 v4, s[20:23], s38 offen offset:1024 lds
    v_mfma_f32_32x32x16_bf16 v[112:127], v[220:223], v[228:231], v[112:127]
    s_waitcnt lgkmcnt(0)
    v_mfma_f32_32x32x16_bf16 v[32:47], v[192:195], v[204:207], v[32:47]
    ds_read_b128 v[224:227], v18 offset:3072
    ds_read_b128 v[228:231], v18 offset:7168
    ds_read_b64_tr_b16 v[212:213], v16 offset:6144
    buffer_load_dwordx4 v4, s[20:23], s38 offen offset:2048 lds
    v_mfma_f32_32x32x16_bf16 v[48:63], v[192:195], v[208:211], v[48:63]
    ds_read_b64_tr_b16 v[214:215], v16 offset:6656
    ds_read_b64_tr_b16 v[216:217], v17 offset:6144
    ds_read_b64_tr_b16 v[218:219], v17 offset:6656
    v_mfma_f32_32x32x16_bf16 v[64:79], v[196:199], v[204:207], v[64:79]
    ds_read_b64_tr_b16 v[220:221], v16 offset:14336
    ds_read_b64_tr_b16 v[222:223], v16 offset:14848
    v_mfma_f32_32x32x16_bf16 v[80:95], v[196:199], v[208:211], v[80:95]
    buffer_load_dwordx4 v4, s[20:23], s38 offen offset:3072 lds
    v_mfma_f32_32x32x16_bf16 v[96:111], v[200:203], v[204:207], v[96:111]
    v_mfma_f32_32x32x16_bf16 v[112:127], v[200:203], v[208:211], v[112:127]
    s_waitcnt lgkmcnt(0) vmcnt(20)
    s_barrier
    ds_read_b128 v[204:207], v22 offset:0
    ds_read_b128 v[208:211], v22 offset:4096
    ds_read_b64_tr_b16 v[192:193], v20 offset:0
    v_mfma_f32_32x32x16_bf16 v[32:47], v[212:215], v[224:227], v[32:47]
    ds_read_b64_tr_b16 v[194:195], v20 offset:512
    ds_read_b64_tr_b16 v[196:197], v21 offset:0
    ds_read_b64_tr_b16 v[198:199], v21 offset:512
    s_add_u32 m0, s36, 0
    s_add_u32 s38, s32, 1769472
    buffer_load_dwordx4 v3, s[16:19], s38 offen lds
    v_mfma_f32_32x32x16_bf16 v[48:63], v[212:215], v[228:231], v[48:63]
    ds_read_b64_tr_b16 v[200:201], v20 offset:8192
    ds_read_b64_tr_b16 v[202:203], v20 offset:8704
    v_mfma_f32_32x32x16_bf16 v[64:79], v[216:219], v[224:227], v[64:79]
    s_add_u32 m0, s36, 1024
    s_add_u32 s38, s32, 1797120
    buffer_load_dwordx4 v3, s[16:19], s38 offen lds
    v_mfma_f32_32x32x16_bf16 v[80:95], v[216:219], v[228:231], v[80:95]
    v_mfma_f32_32x32x16_bf16 v[96:111], v[220:223], v[224:227], v[96:111]
    s_add_u32 m0, s36, 8192
    s_add_u32 s38, s32, 1769600
    buffer_load_dwordx4 v3, s[16:19], s38 offen lds
    v_mfma_f32_32x32x16_bf16 v[112:127], v[220:223], v[228:231], v[112:127]
    s_waitcnt lgkmcnt(0)
    v_mfma_f32_32x32x16_bf16 v[32:47], v[192:195], v[204:207], v[32:47]
    ds_read_b128 v[224:227], v22 offset:1024
    ds_read_b128 v[228:231], v22 offset:5120
    ds_read_b64_tr_b16 v[212:213], v20 offset:2048
    s_add_u32 m0, s36, 9216
    s_add_u32 s38, s32, 1797248
    buffer_load_dwordx4 v3, s[16:19], s38 offen lds
    v_mfma_f32_32x32x16_bf16 v[48:63], v[192:195], v[208:211], v[48:63]
    ds_read_b64_tr_b16 v[214:215], v20 offset:2560
    ds_read_b64_tr_b16 v[216:217], v21 offset:2048
    ds_read_b64_tr_b16 v[218:219], v21 offset:2560
    v_mfma_f32_32x32x16_bf16 v[64:79], v[196:199], v[204:207], v[64:79]
    ds_read_b64_tr_b16 v[220:221], v20 offset:10240
    ds_read_b64_tr_b16 v[222:223], v20 offset:10752
    s_add_u32 m0, s36, 16384
    s_add_u32 s38, s32, 1769728
    buffer_load_dwordx4 v3, s[16:19], s38 offen lds
    v_mfma_f32_32x32x16_bf16 v[80:95], v[196:199], v[208:211], v[80:95]
    v_mfma_f32_32x32x16_bf16 v[96:111], v[200:203], v[204:207], v[96:111]
    s_add_u32 m0, s36, 17408
    s_add_u32 s38, s32, 1797376
    buffer_load_dwordx4 v3, s[16:19], s38 offen lds
    v_mfma_f32_32x32x16_bf16 v[112:127], v[200:203], v[208:211], v[112:127]
    s_waitcnt lgkmcnt(0)
    v_mfma_f32_32x32x16_bf16 v[32:47], v[212:215], v[224:227], v[32:47]
    ds_read_b128 v[204:207], v22 offset:2048
    ds_read_b128 v[208:211], v22 offset:6144
    ds_read_b64_tr_b16 v[192:193], v20 offset:4096
    s_add_u32 m0, s37, 0
    s_add_u32 s38, s34, 32768
    buffer_load_dwordx4 v4, s[20:23], s38 offen lds
    v_mfma_f32_32x32x16_bf16 v[48:63], v[212:215], v[228:231], v[48:63]
    ds_read_b64_tr_b16 v[194:195], v20 offset:4608
    ds_read_b64_tr_b16 v[196:197], v21 offset:4096
    ds_read_b64_tr_b16 v[198:199], v21 offset:4608
    v_mfma_f32_32x32x16_bf16 v[64:79], v[216:219], v[224:227], v[64:79]
    ds_read_b64_tr_b16 v[200:201], v20 offset:12288
    ds_read_b64_tr_b16 v[202:203], v20 offset:12800
    buffer_load_dwordx4 v4, s[20:23], s38 offen offset:1024 lds
    v_mfma_f32_32x32x16_bf16 v[80:95], v[216:219], v[228:231], v[80:95]
    v_mfma_f32_32x32x16_bf16 v[96:111], v[220:223], v[224:227], v[96:111]
    buffer_load_dwordx4 v4, s[20:23], s38 offen offset:2048 lds
    v_mfma_f32_32x32x16_bf16 v[112:127], v[220:223], v[228:231], v[112:127]
    s_waitcnt lgkmcnt(0)
    v_mfma_f32_32x32x16_bf16 v[32:47], v[192:195], v[204:207], v[32:47]
    ds_read_b128 v[224:227], v22 offset:3072
    ds_read_b128 v[228:231], v22 offset:7168
    ds_read_b64_tr_b16 v[212:213], v20 offset:6144
    buffer_load_dwordx4 v4, s[20:23], s38 offen offset:3072 lds
    v_mfma_f32_32x32x16_bf16 v[48:63], v[192:195], v[208:211], v[48:63]
    ds_read_b64_tr_b16 v[214:215], v20 offset:6656
    ds_read_b64_tr_b16 v[216:217], v21 offset:6144
    ds_read_b64_tr_b16 v[218:219], v21 offset:6656
    v_mfma_f32_32x32x16_bf16 v[64:79], v[196:199], v[204:207], v[64:79]
    ds_read_b64_tr_b16 v[220:221], v20 offset:14336
    ds_read_b64_tr_b16 v[222:223], v20 offset:14848
    v_mfma_f32_32x32x16_bf16 v[80:95], v[196:199], v[208:211], v[80:95]
    v_mfma_f32_32x32x16_bf16 v[96:111], v[200:203], v[204:207], v[96:111]
    v_mfma_f32_32x32x16_bf16 v[112:127], v[200:203], v[208:211], v[112:127]
    s_waitcnt lgkmcnt(0) vmcnt(20)
    s_barrier
    ds_read_b128 v[204:207], v26 offset:0
    ds_read_b128 v[208:211], v26 offset:4096
    ds_read_b64_tr_b16 v[192:193], v24 offset:0
    v_mfma_f32_32x32x16_bf16 v[32:47], v[212:215], v[224:227], v[32:47]
    ds_read_b64_tr_b16 v[194:195], v24 offset:512
    ds_read_b64_tr_b16 v[196:197], v25 offset:0
    ds_read_b64_tr_b16 v[198:199], v25 offset:512
    s_add_u32 m0, s36, 40960
    s_add_u32 s38, s32, 1990656
    buffer_load_dwordx4 v3, s[16:19], s38 offen lds
    v_mfma_f32_32x32x16_bf16 v[48:63], v[212:215], v[228:231], v[48:63]
    ds_read_b64_tr_b16 v[200:201], v24 offset:8192
    ds_read_b64_tr_b16 v[202:203], v24 offset:8704
    v_mfma_f32_32x32x16_bf16 v[64:79], v[216:219], v[224:227], v[64:79]
    s_add_u32 m0, s36, 41984
    s_add_u32 s38, s32, 2018304
    buffer_load_dwordx4 v3, s[16:19], s38 offen lds
    v_mfma_f32_32x32x16_bf16 v[80:95], v[216:219], v[228:231], v[80:95]
    v_mfma_f32_32x32x16_bf16 v[96:111], v[220:223], v[224:227], v[96:111]
    s_add_u32 m0, s36, 49152
    s_add_u32 s38, s32, 1990784
    buffer_load_dwordx4 v3, s[16:19], s38 offen lds
    v_mfma_f32_32x32x16_bf16 v[112:127], v[220:223], v[228:231], v[112:127]
    s_waitcnt lgkmcnt(0)
    v_mfma_f32_32x32x16_bf16 v[32:47], v[192:195], v[204:207], v[32:47]
    ds_read_b128 v[224:227], v26 offset:1024
    ds_read_b128 v[228:231], v26 offset:5120
    ds_read_b64_tr_b16 v[212:213], v24 offset:2048
    s_add_u32 m0, s36, 50176
    s_add_u32 s38, s32, 2018432
    buffer_load_dwordx4 v3, s[16:19], s38 offen lds
    v_mfma_f32_32x32x16_bf16 v[48:63], v[192:195], v[208:211], v[48:63]
    ds_read_b64_tr_b16 v[214:215], v24 offset:2560
    ds_read_b64_tr_b16 v[216:217], v25 offset:2048
    ds_read_b64_tr_b16 v[218:219], v25 offset:2560
    v_mfma_f32_32x32x16_bf16 v[64:79], v[196:199], v[204:207], v[64:79]
    ds_read_b64_tr_b16 v[220:221], v24 offset:10240
    ds_read_b64_tr_b16 v[222:223], v24 offset:10752
    s_add_u32 m0, s36, 57344
    s_add_u32 s38, s32, 1990912
    buffer_load_dwordx4 v3, s[16:19], s38 offen lds
    v_mfma_f32_32x32x16_bf16 v[80:95], v[196:199], v[208:211], v[80:95]
    v_mfma_f32_32x32x16_bf16 v[96:111], v[200:203], v[204:207], v[96:111]
    s_add_u32 m0, s36, 58368
    s_add_u32 s38, s32, 2018560
    buffer_load_dwordx4 v3, s[16:19], s38 offen lds
    v_mfma_f32_32x32x16_bf16 v[112:127], v[200:203], v[208:211], v[112:127]
    s_waitcnt lgkmcnt(0)
    v_mfma_f32_32x32x16_bf16 v[32:47], v[212:215], v[224:227], v[32:47]
    ds_read_b128 v[204:207], v26 offset:2048
    ds_read_b128 v[208:211], v26 offset:6144
    ds_read_b64_tr_b16 v[192:193], v24 offset:4096
    s_add_u32 m0, s37, 40960
    s_add_u32 s38, s34, 36864
    buffer_load_dwordx4 v4, s[20:23], s38 offen lds
    v_mfma_f32_32x32x16_bf16 v[48:63], v[212:215], v[228:231], v[48:63]
    ds_read_b64_tr_b16 v[194:195], v24 offset:4608
    ds_read_b64_tr_b16 v[196:197], v25 offset:4096
    ds_read_b64_tr_b16 v[198:199], v25 offset:4608
    v_mfma_f32_32x32x16_bf16 v[64:79], v[216:219], v[224:227], v[64:79]
    ds_read_b64_tr_b16 v[200:201], v24 offset:12288
    ds_read_b64_tr_b16 v[202:203], v24 offset:12800
    buffer_load_dwordx4 v4, s[20:23], s38 offen offset:1024 lds
    v_mfma_f32_32x32x16_bf16 v[80:95], v[216:219], v[228:231], v[80:95]
    v_mfma_f32_32x32x16_bf16 v[96:111], v[220:223], v[224:227], v[96:111]
    buffer_load_dwordx4 v4, s[20:23], s38 offen offset:2048 lds
    v_mfma_f32_32x32x16_bf16 v[112:127], v[220:223], v[228:231], v[112:127]
    s_waitcnt lgkmcnt(0)
    v_mfma_f32_32x32x16_bf16 v[32:47], v[192:195], v[204:207], v[32:47]
    ds_read_b128 v[224:227], v26 offset:3072
    ds_read_b128 v[228:231], v26 offset:7168
    ds_read_b64_tr_b16 v[212:213], v24 offset:6144
    buffer_load_dwordx4 v4, s[20:23], s38 offen offset:3072 lds
    v_mfma_f32_32x32x16_bf16 v[48:63], v[192:195], v[208:211], v[48:63]
    ds_read_b64_tr_b16 v[214:215], v24 offset:6656
    ds_read_b64_tr_b16 v[216:217], v25 offset:6144
    ds_read_b64_tr_b16 v[218:219], v25 offset:6656
    v_mfma_f32_32x32x16_bf16 v[64:79], v[196:199], v[204:207], v[64:79]
    ds_read_b64_tr_b16 v[220:221], v24 offset:14336
    ds_read_b64_tr_b16 v[222:223], v24 offset:14848
    v_mfma_f32_32x32x16_bf16 v[80:95], v[196:199], v[208:211], v[80:95]
    v_mfma_f32_32x32x16_bf16 v[96:111], v[200:203], v[204:207], v[96:111]
    v_mfma_f32_32x32x16_bf16 v[112:127], v[200:203], v[208:211], v[112:127]
    s_waitcnt lgkmcnt(0) vmcnt(20)
    s_barrier
    ds_read_b128 v[204:207], v30 offset:0
    ds_read_b128 v[208:211], v30 offset:4096
    ds_read_b64_tr_b16 v[192:193], v28 offset:0
    v_mfma_f32_32x32x16_bf16 v[32:47], v[212:215], v[224:227], v[32:47]
    ds_read_b64_tr_b16 v[194:195], v28 offset:512
    ds_read_b64_tr_b16 v[196:197], v29 offset:0
    ds_read_b64_tr_b16 v[198:199], v29 offset:512
    v_mfma_f32_32x32x16_bf16 v[48:63], v[212:215], v[228:231], v[48:63]
    ds_read_b64_tr_b16 v[200:201], v28 offset:8192
    ds_read_b64_tr_b16 v[202:203], v28 offset:8704
    v_mfma_f32_32x32x16_bf16 v[64:79], v[216:219], v[224:227], v[64:79]
    v_mfma_f32_32x32x16_bf16 v[80:95], v[216:219], v[228:231], v[80:95]
    v_mfma_f32_32x32x16_bf16 v[96:111], v[220:223], v[224:227], v[96:111]
    v_mfma_f32_32x32x16_bf16 v[112:127], v[220:223], v[228:231], v[112:127]
    s_waitcnt lgkmcnt(0)
    v_mfma_f32_32x32x16_bf16 v[32:47], v[192:195], v[204:207], v[32:47]
    ds_read_b128 v[224:227], v30 offset:1024
    ds_read_b128 v[228:231], v30 offset:5120
    ds_read_b64_tr_b16 v[212:213], v28 offset:2048
    v_mfma_f32_32x32x16_bf16 v[48:63], v[192:195], v[208:211], v[48:63]
    ds_read_b64_tr_b16 v[214:215], v28 offset:2560
    ds_read_b64_tr_b16 v[216:217], v29 offset:2048
    ds_read_b64_tr_b16 v[218:219], v29 offset:2560
    v_mfma_f32_32x32x16_bf16 v[64:79], v[196:199], v[204:207], v[64:79]
    ds_read_b64_tr_b16 v[220:221], v28 offset:10240
    ds_read_b64_tr_b16 v[222:223], v28 offset:10752
    v_mfma_f32_32x32x16_bf16 v[80:95], v[196:199], v[208:211], v[80:95]
    v_mfma_f32_32x32x16_bf16 v[96:111], v[200:203], v[204:207], v[96:111]
    v_mfma_f32_32x32x16_bf16 v[112:127], v[200:203], v[208:211], v[112:127]
    s_waitcnt lgkmcnt(0)
    v_mfma_f32_32x32x16_bf16 v[32:47], v[212:215], v[224:227], v[32:47]
    ds_read_b128 v[204:207], v30 offset:2048
    ds_read_b128 v[208:211], v30 offset:6144
    ds_read_b64_tr_b16 v[192:193], v28 offset:4096
    v_mfma_f32_32x32x16_bf16 v[48:63], v[212:215], v[228:231], v[48:63]
    ds_read_b64_tr_b16 v[194:195], v28 offset:4608
    ds_read_b64_tr_b16 v[196:197], v29 offset:4096
    ds_read_b64_tr_b16 v[198:199], v29 offset:4608
    v_mfma_f32_32x32x16_bf16 v[64:79], v[216:219], v[224:227], v[64:79]
    ds_read_b64_tr_b16 v[200:201], v28 offset:12288
    ds_read_b64_tr_b16 v[202:203], v28 offset:12800
    v_mfma_f32_32x32x16_bf16 v[80:95], v[216:219], v[228:231], v[80:95]
    v_mfma_f32_32x32x16_bf16 v[96:111], v[220:223], v[224:227], v[96:111]
    v_mfma_f32_32x32x16_bf16 v[112:127], v[220:223], v[228:231], v[112:127]
    s_waitcnt lgkmcnt(0)
    v_mfma_f32_32x32x16_bf16 v[32:47], v[192:195], v[204:207], v[32:47]
    ds_read_b128 v[224:227], v30 offset:3072
    ds_read_b128 v[228:231], v30 offset:7168
    ds_read_b64_tr_b16 v[212:213], v28 offset:6144
    v_mfma_f32_32x32x16_bf16 v[48:63], v[192:195], v[208:211], v[48:63]
    ds_read_b64_tr_b16 v[214:215], v28 offset:6656
    ds_read_b64_tr_b16 v[216:217], v29 offset:6144
    ds_read_b64_tr_b16 v[218:219], v29 offset:6656
    v_mfma_f32_32x32x16_bf16 v[64:79], v[196:199], v[204:207], v[64:79]
    ds_read_b64_tr_b16 v[220:221], v28 offset:14336
    ds_read_b64_tr_b16 v[222:223], v28 offset:14848
    v_mfma_f32_32x32x16_bf16 v[80:95], v[196:199], v[208:211], v[80:95]
    v_mfma_f32_32x32x16_bf16 v[96:111], v[200:203], v[204:207], v[96:111]
    v_mfma_f32_32x32x16_bf16 v[112:127], v[200:203], v[208:211], v[112:127]
    s_waitcnt lgkmcnt(0) vmcnt(10)
    s_barrier
    ds_read_b128 v[204:207], v18 offset:0
    ds_read_b128 v[208:211], v18 offset:4096
    ds_read_b64_tr_b16 v[192:193], v16 offset:0
    v_mfma_f32_32x32x16_bf16 v[32:47], v[212:215], v[224:227], v[32:47]
    ds_read_b64_tr_b16 v[194:195], v16 offset:512
    ds_read_b64_tr_b16 v[196:197], v17 offset:0
    ds_read_b64_tr_b16 v[198:199], v17 offset:512
    v_mfma_f32_32x32x16_bf16 v[48:63], v[212:215], v[228:231], v[48:63]
    ds_read_b64_tr_b16 v[200:201], v16 offset:8192
    ds_read_b64_tr_b16 v[202:203], v16 offset:8704
    v_mfma_f32_32x32x16_bf16 v[64:79], v[216:219], v[224:227], v[64:79]
    v_mfma_f32_32x32x16_bf16 v[80:95], v[216:219], v[228:231], v[80:95]
    v_mfma_f32_32x32x16_bf16 v[96:111], v[220:223], v[224:227], v[96:111]
    v_mfma_f32_32x32x16_bf16 v[112:127], v[220:223], v[228:231], v[112:127]
    s_waitcnt lgkmcnt(0)
    v_mfma_f32_32x32x16_bf16 v[32:47], v[192:195], v[204:207], v[32:47]
    ds_read_b128 v[224:227], v18 offset:1024
    ds_read_b128 v[228:231], v18 offset:5120
    ds_read_b64_tr_b16 v[212:213], v16 offset:2048
    v_mfma_f32_32x32x16_bf16 v[48:63], v[192:195], v[208:211], v[48:63]
    ds_read_b64_tr_b16 v[214:215], v16 offset:2560
    ds_read_b64_tr_b16 v[216:217], v17 offset:2048
    ds_read_b64_tr_b16 v[218:219], v17 offset:2560
    v_mfma_f32_32x32x16_bf16 v[64:79], v[196:199], v[204:207], v[64:79]
    ds_read_b64_tr_b16 v[220:221], v16 offset:10240
    ds_read_b64_tr_b16 v[222:223], v16 offset:10752
    v_mfma_f32_32x32x16_bf16 v[80:95], v[196:199], v[208:211], v[80:95]
    v_mfma_f32_32x32x16_bf16 v[96:111], v[200:203], v[204:207], v[96:111]
    v_mfma_f32_32x32x16_bf16 v[112:127], v[200:203], v[208:211], v[112:127]
    s_waitcnt lgkmcnt(0)
    v_mfma_f32_32x32x16_bf16 v[32:47], v[212:215], v[224:227], v[32:47]
    ds_read_b128 v[204:207], v18 offset:2048
    ds_read_b128 v[208:211], v18 offset:6144
    ds_read_b64_tr_b16 v[192:193], v16 offset:4096
    v_mfma_f32_32x32x16_bf16 v[48:63], v[212:215], v[228:231], v[48:63]
    ds_read_b64_tr_b16 v[194:195], v16 offset:4608
    ds_read_b64_tr_b16 v[196:197], v17 offset:4096
    ds_read_b64_tr_b16 v[198:199], v17 offset:4608
    v_mfma_f32_32x32x16_bf16 v[64:79], v[216:219], v[224:227], v[64:79]
    ds_read_b64_tr_b16 v[200:201], v16 offset:12288
    ds_read_b64_tr_b16 v[202:203], v16 offset:12800
    v_mfma_f32_32x32x16_bf16 v[80:95], v[216:219], v[228:231], v[80:95]
    v_mfma_f32_32x32x16_bf16 v[96:111], v[220:223], v[224:227], v[96:111]
    v_mfma_f32_32x32x16_bf16 v[112:127], v[220:223], v[228:231], v[112:127]
    s_waitcnt lgkmcnt(0)
    v_mfma_f32_32x32x16_bf16 v[32:47], v[192:195], v[204:207], v[32:47]
    ds_read_b128 v[224:227], v18 offset:3072
    ds_read_b128 v[228:231], v18 offset:7168
    ds_read_b64_tr_b16 v[212:213], v16 offset:6144
    v_mfma_f32_32x32x16_bf16 v[48:63], v[192:195], v[208:211], v[48:63]
    ds_read_b64_tr_b16 v[214:215], v16 offset:6656
    ds_read_b64_tr_b16 v[216:217], v17 offset:6144
    ds_read_b64_tr_b16 v[218:219], v17 offset:6656
    v_mfma_f32_32x32x16_bf16 v[64:79], v[196:199], v[204:207], v[64:79]
    ds_read_b64_tr_b16 v[220:221], v16 offset:14336
    ds_read_b64_tr_b16 v[222:223], v16 offset:14848
    v_mfma_f32_32x32x16_bf16 v[80:95], v[196:199], v[208:211], v[80:95]
    v_mfma_f32_32x32x16_bf16 v[96:111], v[200:203], v[204:207], v[96:111]
    v_mfma_f32_32x32x16_bf16 v[112:127], v[200:203], v[208:211], v[112:127]
    s_waitcnt lgkmcnt(0) vmcnt(0)
    s_barrier
    ds_read_b64_tr_b16 v[232:233], v20 offset:0
    ds_read_b64_tr_b16 v[234:235], v20 offset:512
    ds_read_b128 a[0:3], v22 offset:0
    v_mfma_f32_32x32x16_bf16 v[32:47], v[212:215], v[224:227], v[32:47]
    ds_read_b128 a[4:7], v22 offset:4096
    ds_read_b64_tr_b16 v[236:237], v20 offset:2048
    ds_read_b64_tr_b16 v[238:239], v20 offset:2560
    v_mfma_f32_32x32x16_bf16 v[48:63], v[212:215], v[228:231], v[48:63]
    ds_read_b128 a[8:11], v22 offset:1024
    ds_read_b128 a[12:15], v22 offset:5120
    ds_read_b64_tr_b16 v[240:241], v20 offset:4096
    v_mfma_f32_32x32x16_bf16 v[64:79], v[216:219], v[224:227], v[64:79]
    ds_read_b64_tr_b16 v[242:243], v20 offset:4608
    ds_read_b128 a[16:19], v22 offset:2048
    ds_read_b128 a[20:23], v22 offset:6144
    v_mfma_f32_32x32x16_bf16 v[80:95], v[216:219], v[228:231], v[80:95]
    ds_read_b64_tr_b16 v[244:245], v20 offset:6144
    ds_read_b64_tr_b16 v[246:247], v20 offset:6656
    ds_read_b128 a[24:27], v22 offset:3072
    v_mfma_f32_32x32x16_bf16 v[96:111], v[220:223], v[224:227], v[96:111]
    ds_read_b128 a[28:31], v22 offset:7168
    v_mfma_f32_32x32x16_bf16 v[112:127], v[220:223], v[228:231], v[112:127]
    s_waitcnt lgkmcnt(0)
    v_mfma_f32_32x32x16_bf16 v[32:47], v[232:235], a[0:3], v[32:47]
    ds_read_b64_tr_b16 v[176:177], v21 offset:0
    ds_read_b64_tr_b16 v[178:179], v21 offset:512
    ds_read_b64_tr_b16 v[180:181], v21 offset:2048
    s_mov_b32 s42, 0xbdd2d3e8
    s_mov_b32 s43, s42
    v_mov_b32 v8, 0xc0135761
    v_mfma_f32_32x32x16_bf16 v[48:63], v[232:235], a[4:7], v[48:63]
    ds_read_b64_tr_b16 v[182:183], v21 offset:2560
    ds_read_b64_tr_b16 v[184:185], v21 offset:4096
    ds_read_b64_tr_b16 v[186:187], v21 offset:4608
    v_mov_b32 v9, 0xc0135761
    v_bfe_u32 v6, v2, 4, 1
    v_mfma_f32_32x32x16_bf16 v[32:47], v[236:239], a[8:11], v[32:47]
    ds_read_b64_tr_b16 v[188:189], v21 offset:6144
    ds_read_b64_tr_b16 v[190:191], v21 offset:6656
    v_mul_u32_u24 v6, 76800, v6
    v_lshl_add_u32 v6, v5, 9, v6
    v_mfma_f32_32x32x16_bf16 v[48:63], v[236:239], a[12:15], v[48:63]
    v_and_b32 v7, 15, v2
    v_lshl_add_u32 v6, v7, 4, v6
    v_mfma_f32_32x32x16_bf16 v[32:47], v[240:243], a[16:19], v[32:47]
    s_lshl_b32 s38, s12, 1
    s_add_u32 s38, s38, s15
    s_mul_i32 s38, s38, 307200
    v_mfma_f32_32x32x16_bf16 v[48:63], v[240:243], a[20:23], v[48:63]
    s_mul_i32 s39, s13, 6144
    s_mul_i32 s40, s14, 3072
    v_mfma_f32_32x32x16_bf16 v[32:47], v[244:247], a[24:27], v[32:47]
    s_add_u32 s38, s38, s39
    s_add_u32 s38, s38, s40
    v_mfma_f32_32x32x16_bf16 v[48:63], v[244:247], a[28:31], v[48:63]
    s_add_u32 s39, s38, 153600
    s_waitcnt lgkmcnt(0)
    v_mfma_f32_32x32x16_bf16 v[64:79], v[176:179], a[0:3], v[64:79]
    v_mfma_f32_32x32x16_bf16 v[80:95], v[176:179], a[4:7], v[80:95]
    v_mfma_f32_32x32x16_bf16 v[64:79], v[180:183], a[8:11], v[64:79]
    v_mfma_f32_32x32x16_bf16 v[80:95], v[180:183], a[12:15], v[80:95]
    v_pk_mul_f32 v[128:129], v[32:33], v[32:33]
    v_pk_mul_f32 v[130:131], v[34:35], v[34:35]
    v_pk_mul_f32 v[132:133], v[36:37], v[36:37]
    v_pk_mul_f32 v[134:135], v[38:39], v[38:39]
    v_pk_mul_f32 v[136:137], v[40:41], v[40:41]
    v_pk_mul_f32 v[138:139], v[42:43], v[42:43]
    v_pk_mul_f32 v[140:141], v[44:45], v[44:45]
    v_pk_mul_f32 v[142:143], v[46:47], v[46:47]
    v_mfma_f32_32x32x16_bf16 v[64:79], v[184:187], a[16:19], v[64:79]
    v_pk_fma_f32 v[128:129], v[128:129], s[42:43], v[8:9]
    v_pk_fma_f32 v[130:131], v[130:131], s[42:43], v[8:9]
    v_pk_fma_f32 v[132:133], v[132:133], s[42:43], v[8:9]
    v_pk_fma_f32 v[134:135], v[134:135], s[42:43], v[8:9]
    v_pk_fma_f32 v[136:137], v[136:137], s[42:43], v[8:9]
    v_pk_fma_f32 v[138:139], v[138:139], s[42:43], v[8:9]
    v_pk_fma_f32 v[140:141], v[140:141], s[42:43], v[8:9]
    v_pk_fma_f32 v[142:143], v[142:143], s[42:43], v[8:9]
    v_mfma_f32_32x32x16_bf16 v[80:95], v[184:187], a[20:23], v[80:95]
    v_pk_mul_f32 v[128:129], v[128:129], v[32:33]
    v_pk_mul_f32 v[130:131], v[130:131], v[34:35]
    v_pk_mul_f32 v[132:133], v[132:133], v[36:37]
    v_pk_mul_f32 v[134:135], v[134:135], v[38:39]
    v_pk_mul_f32 v[136:137], v[136:137], v[40:41]
    v_pk_mul_f32 v[138:139], v[138:139], v[42:43]
    v_pk_mul_f32 v[140:141], v[140:141], v[44:45]
    v_pk_mul_f32 v[142:143], v[142:143], v[46:47]
    v_mfma_f32_32x32x16_bf16 v[64:79], v[188:191], a[24:27], v[64:79]
    v_exp_f32 v128, v128
    v_exp_f32 v129, v129
    v_exp_f32 v130, v130
    v_exp_f32 v131, v131
    v_exp_f32 v132, v132
    v_exp_f32 v133, v133
    v_exp_f32 v134, v134
    v_exp_f32 v135, v135
    v_mfma_f32_32x32x16_bf16 v[80:95], v[188:191], a[28:31], v[80:95]
    v_exp_f32 v136, v136
    v_exp_f32 v137, v137
    v_exp_f32 v138, v138
    v_exp_f32 v139, v139
    v_exp_f32 v140, v140
    v_exp_f32 v141, v141
    v_exp_f32 v142, v142
    v_exp_f32 v143, v143
    ds_read_b64_tr_b16 v[232:233], v20 offset:8192
    ds_read_b64_tr_b16 v[234:235], v20 offset:8704
    ds_read_b64_tr_b16 v[236:237], v20 offset:10240
    ds_read_b64_tr_b16 v[238:239], v20 offset:10752
    ds_read_b64_tr_b16 v[240:241], v20 offset:12288
    ds_read_b64_tr_b16 v[242:243], v20 offset:12800
    ds_read_b64_tr_b16 v[244:245], v20 offset:14336
    ds_read_b64_tr_b16 v[246:247], v20 offset:14848
    v_pk_add_f32 v[128:129], v[128:129], 1.0 op_sel_hi:[1,0]
    v_pk_add_f32 v[130:131], v[130:131], 1.0 op_sel_hi:[1,0]
    v_pk_add_f32 v[132:133], v[132:133], 1.0 op_sel_hi:[1,0]
    v_pk_add_f32 v[134:135], v[134:135], 1.0 op_sel_hi:[1,0]
    v_pk_add_f32 v[136:137], v[136:137], 1.0 op_sel_hi:[1,0]
    v_pk_add_f32 v[138:139], v[138:139], 1.0 op_sel_hi:[1,0]
    v_pk_add_f32 v[140:141], v[140:141], 1.0 op_sel_hi:[1,0]
    v_pk_add_f32 v[142:143], v[142:143], 1.0 op_sel_hi:[1,0]
    v_rcp_f32 v128, v128
    v_rcp_f32 v129, v129
    v_rcp_f32 v130, v130
    v_rcp_f32 v131, v131
    v_rcp_f32 v132, v132
    v_rcp_f32 v133, v133
    v_rcp_f32 v134, v134
    v_rcp_f32 v135, v135
    v_rcp_f32 v136, v136
    v_rcp_f32 v137, v137
    v_rcp_f32 v138, v138
    v_rcp_f32 v139, v139
    v_rcp_f32 v140, v140
    v_rcp_f32 v141, v141
    v_rcp_f32 v142, v142
    v_rcp_f32 v143, v143
    v_pk_mul_f32 v[128:129], v[128:129], v[32:33]
    v_pk_mul_f32 v[130:131], v[130:131], v[34:35]
    v_pk_mul_f32 v[132:133], v[132:133], v[36:37]
    v_pk_mul_f32 v[134:135], v[134:135], v[38:39]
    v_pk_mul_f32 v[136:137], v[136:137], v[40:41]
    v_pk_mul_f32 v[138:139], v[138:139], v[42:43]
    v_pk_mul_f32 v[140:141], v[140:141], v[44:45]
    v_pk_mul_f32 v[142:143], v[142:143], v[46:47]
    v_cvt_pk_bf16_f32 v248, v128, v129
    v_cvt_pk_bf16_f32 v249, v130, v131
    v_cvt_pk_bf16_f32 v250, v132, v133
    v_cvt_pk_bf16_f32 v251, v134, v135
    v_cvt_pk_bf16_f32 v252, v136, v137
    v_cvt_pk_bf16_f32 v253, v138, v139
    v_cvt_pk_bf16_f32 v254, v140, v141
    v_cvt_pk_bf16_f32 v255, v142, v143
    buffer_store_dwordx4 v[248:251], v6, s[28:31], s38 offen offset:0 sc0 sc1
    buffer_store_dwordx4 v[252:255], v6, s[28:31], s38 offen offset:256 sc0 sc1
    v_pk_mul_f32 v[144:145], v[48:49], v[48:49]
    v_pk_mul_f32 v[146:147], v[50:51], v[50:51]
    v_pk_mul_f32 v[148:149], v[52:53], v[52:53]
    v_pk_mul_f32 v[150:151], v[54:55], v[54:55]
    v_pk_mul_f32 v[152:153], v[56:57], v[56:57]
    v_pk_mul_f32 v[154:155], v[58:59], v[58:59]
    v_pk_mul_f32 v[156:157], v[60:61], v[60:61]
    v_pk_mul_f32 v[158:159], v[62:63], v[62:63]
    v_pk_fma_f32 v[144:145], v[144:145], s[42:43], v[8:9]
    v_pk_fma_f32 v[146:147], v[146:147], s[42:43], v[8:9]
    v_pk_fma_f32 v[148:149], v[148:149], s[42:43], v[8:9]
    v_pk_fma_f32 v[150:151], v[150:151], s[42:43], v[8:9]
    v_pk_fma_f32 v[152:153], v[152:153], s[42:43], v[8:9]
    v_pk_fma_f32 v[154:155], v[154:155], s[42:43], v[8:9]
    v_pk_fma_f32 v[156:157], v[156:157], s[42:43], v[8:9]
    v_pk_fma_f32 v[158:159], v[158:159], s[42:43], v[8:9]
    v_pk_mul_f32 v[144:145], v[144:145], v[48:49]
    v_pk_mul_f32 v[146:147], v[146:147], v[50:51]
    v_pk_mul_f32 v[148:149], v[148:149], v[52:53]
    v_pk_mul_f32 v[150:151], v[150:151], v[54:55]
    v_pk_mul_f32 v[152:153], v[152:153], v[56:57]
    v_pk_mul_f32 v[154:155], v[154:155], v[58:59]
    v_pk_mul_f32 v[156:157], v[156:157], v[60:61]
    v_pk_mul_f32 v[158:159], v[158:159], v[62:63]
    v_exp_f32 v144, v144
    v_exp_f32 v145, v145
    v_exp_f32 v146, v146
    v_exp_f32 v147, v147
    v_exp_f32 v148, v148
    v_exp_f32 v149, v149
    v_exp_f32 v150, v150
    v_exp_f32 v151, v151
    v_exp_f32 v152, v152
    v_exp_f32 v153, v153
    v_exp_f32 v154, v154
    v_exp_f32 v155, v155
    v_exp_f32 v156, v156
    v_exp_f32 v157, v157
    v_exp_f32 v158, v158
    v_exp_f32 v159, v159
    v_pk_add_f32 v[144:145], v[144:145], 1.0 op_sel_hi:[1,0]
    v_pk_add_f32 v[146:147], v[146:147], 1.0 op_sel_hi:[1,0]
    v_pk_add_f32 v[148:149], v[148:149], 1.0 op_sel_hi:[1,0]
    v_pk_add_f32 v[150:151], v[150:151], 1.0 op_sel_hi:[1,0]
    v_pk_add_f32 v[152:153], v[152:153], 1.0 op_sel_hi:[1,0]
    v_pk_add_f32 v[154:155], v[154:155], 1.0 op_sel_hi:[1,0]
    v_pk_add_f32 v[156:157], v[156:157], 1.0 op_sel_hi:[1,0]
    v_pk_add_f32 v[158:159], v[158:159], 1.0 op_sel_hi:[1,0]
    v_rcp_f32 v144, v144
    v_rcp_f32 v145, v145
    v_rcp_f32 v146, v146
    v_rcp_f32 v147, v147
    v_rcp_f32 v148, v148
    v_rcp_f32 v149, v149
    v_rcp_f32 v150, v150
    v_rcp_f32 v151, v151
    v_rcp_f32 v152, v152
    v_rcp_f32 v153, v153
    v_rcp_f32 v154, v154
    v_rcp_f32 v155, v155
    v_rcp_f32 v156, v156
    v_rcp_f32 v157, v157
    v_rcp_f32 v158, v158
    v_rcp_f32 v159, v159
    v_pk_mul_f32 v[144:145], v[144:145], v[48:49]
    v_pk_mul_f32 v[146:147], v[146:147], v[50:51]
    v_pk_mul_f32 v[148:149], v[148:149], v[52:53]
    v_pk_mul_f32 v[150:151], v[150:151], v[54:55]
    v_pk_mul_f32 v[152:153], v[152:153], v[56:57]
    v_pk_mul_f32 v[154:155], v[154:155], v[58:59]
    v_pk_mul_f32 v[156:157], v[156:157], v[60:61]
    v_pk_mul_f32 v[158:159], v[158:159], v[62:63]
    v_cvt_pk_bf16_f32 v248, v144, v145
    v_cvt_pk_bf16_f32 v249, v146, v147
    v_cvt_pk_bf16_f32 v250, v148, v149
    v_cvt_pk_bf16_f32 v251, v150, v151
    v_cvt_pk_bf16_f32 v252, v152, v153
    v_cvt_pk_bf16_f32 v253, v154, v155
    v_cvt_pk_bf16_f32 v254, v156, v157
    v_cvt_pk_bf16_f32 v255, v158, v159
    buffer_store_dwordx4 v[248:251], v6, s[28:31], s39 offen offset:0 sc0 sc1
    buffer_store_dwordx4 v[252:255], v6, s[28:31], s39 offen offset:256 sc0 sc1
    s_waitcnt lgkmcnt(0)
    v_mfma_f32_32x32x16_bf16 v[96:111], v[232:235], a[0:3], v[96:111]
    v_mfma_f32_32x32x16_bf16 v[112:127], v[232:235], a[4:7], v[112:127]
    v_mfma_f32_32x32x16_bf16 v[96:111], v[236:239], a[8:11], v[96:111]
    v_mfma_f32_32x32x16_bf16 v[112:127], v[236:239], a[12:15], v[112:127]
    v_pk_mul_f32 v[128:129], v[64:65], v[64:65]
    v_pk_mul_f32 v[130:131], v[66:67], v[66:67]
    v_pk_mul_f32 v[132:133], v[68:69], v[68:69]
    v_pk_mul_f32 v[134:135], v[70:71], v[70:71]
    v_pk_mul_f32 v[136:137], v[72:73], v[72:73]
    v_pk_mul_f32 v[138:139], v[74:75], v[74:75]
    v_pk_mul_f32 v[140:141], v[76:77], v[76:77]
    v_pk_mul_f32 v[142:143], v[78:79], v[78:79]
    v_mfma_f32_32x32x16_bf16 v[96:111], v[240:243], a[16:19], v[96:111]
    v_pk_fma_f32 v[128:129], v[128:129], s[42:43], v[8:9]
    v_pk_fma_f32 v[130:131], v[130:131], s[42:43], v[8:9]
    v_pk_fma_f32 v[132:133], v[132:133], s[42:43], v[8:9]
    v_pk_fma_f32 v[134:135], v[134:135], s[42:43], v[8:9]
    v_pk_fma_f32 v[136:137], v[136:137], s[42:43], v[8:9]
    v_pk_fma_f32 v[138:139], v[138:139], s[42:43], v[8:9]
    v_pk_fma_f32 v[140:141], v[140:141], s[42:43], v[8:9]
    v_pk_fma_f32 v[142:143], v[142:143], s[42:43], v[8:9]
    v_mfma_f32_32x32x16_bf16 v[112:127], v[240:243], a[20:23], v[112:127]
    v_pk_mul_f32 v[128:129], v[128:129], v[64:65]
    v_pk_mul_f32 v[130:131], v[130:131], v[66:67]
    v_pk_mul_f32 v[132:133], v[132:133], v[68:69]
    v_pk_mul_f32 v[134:135], v[134:135], v[70:71]
    v_pk_mul_f32 v[136:137], v[136:137], v[72:73]
    v_pk_mul_f32 v[138:139], v[138:139], v[74:75]
    v_pk_mul_f32 v[140:141], v[140:141], v[76:77]
    v_pk_mul_f32 v[142:143], v[142:143], v[78:79]
    v_mfma_f32_32x32x16_bf16 v[96:111], v[244:247], a[24:27], v[96:111]
    v_exp_f32 v128, v128
    v_exp_f32 v129, v129
    v_exp_f32 v130, v130
    v_exp_f32 v131, v131
    v_exp_f32 v132, v132
    v_exp_f32 v133, v133
    v_exp_f32 v134, v134
    v_exp_f32 v135, v135
    v_mfma_f32_32x32x16_bf16 v[112:127], v[244:247], a[28:31], v[112:127]
    v_exp_f32 v136, v136
    v_exp_f32 v137, v137
    v_exp_f32 v138, v138
    v_exp_f32 v139, v139
    v_exp_f32 v140, v140
    v_exp_f32 v141, v141
    v_exp_f32 v142, v142
    v_exp_f32 v143, v143
    v_pk_add_f32 v[128:129], v[128:129], 1.0 op_sel_hi:[1,0]
    v_pk_add_f32 v[130:131], v[130:131], 1.0 op_sel_hi:[1,0]
    v_pk_add_f32 v[132:133], v[132:133], 1.0 op_sel_hi:[1,0]
    v_pk_add_f32 v[134:135], v[134:135], 1.0 op_sel_hi:[1,0]
    v_pk_add_f32 v[136:137], v[136:137], 1.0 op_sel_hi:[1,0]
    v_pk_add_f32 v[138:139], v[138:139], 1.0 op_sel_hi:[1,0]
    v_pk_add_f32 v[140:141], v[140:141], 1.0 op_sel_hi:[1,0]
    v_pk_add_f32 v[142:143], v[142:143], 1.0 op_sel_hi:[1,0]
    v_rcp_f32 v128, v128
    v_rcp_f32 v129, v129
    v_rcp_f32 v130, v130
    v_rcp_f32 v131, v131
    v_rcp_f32 v132, v132
    v_rcp_f32 v133, v133
    v_rcp_f32 v134, v134
    v_rcp_f32 v135, v135
    v_rcp_f32 v136, v136
    v_rcp_f32 v137, v137
    v_rcp_f32 v138, v138
    v_rcp_f32 v139, v139
    v_rcp_f32 v140, v140
    v_rcp_f32 v141, v141
    v_rcp_f32 v142, v142
    v_rcp_f32 v143, v143
    v_pk_mul_f32 v[128:129], v[128:129], v[64:65]
    v_pk_mul_f32 v[130:131], v[130:131], v[66:67]
    v_pk_mul_f32 v[132:133], v[132:133], v[68:69]
    v_pk_mul_f32 v[134:135], v[134:135], v[70:71]
    v_pk_mul_f32 v[136:137], v[136:137], v[72:73]
    v_pk_mul_f32 v[138:139], v[138:139], v[74:75]
    v_pk_mul_f32 v[140:141], v[140:141], v[76:77]
    v_pk_mul_f32 v[142:143], v[142:143], v[78:79]
    v_cvt_pk_bf16_f32 v248, v128, v129
    v_cvt_pk_bf16_f32 v249, v130, v131
    v_cvt_pk_bf16_f32 v250, v132, v133
    v_cvt_pk_bf16_f32 v251, v134, v135
    v_cvt_pk_bf16_f32 v252, v136, v137
    v_cvt_pk_bf16_f32 v253, v138, v139
    v_cvt_pk_bf16_f32 v254, v140, v141
    v_cvt_pk_bf16_f32 v255, v142, v143
    buffer_store_dwordx4 v[248:251], v6, s[28:31], s38 offen offset:1024 sc0 sc1
    buffer_store_dwordx4 v[252:255], v6, s[28:31], s38 offen offset:1280 sc0 sc1
    v_pk_mul_f32 v[144:145], v[80:81], v[80:81]
    v_pk_mul_f32 v[146:147], v[82:83], v[82:83]
    v_pk_mul_f32 v[148:149], v[84:85], v[84:85]
    v_pk_mul_f32 v[150:151], v[86:87], v[86:87]
    v_pk_mul_f32 v[152:153], v[88:89], v[88:89]
    v_pk_mul_f32 v[154:155], v[90:91], v[90:91]
    v_pk_mul_f32 v[156:157], v[92:93], v[92:93]
    v_pk_mul_f32 v[158:159], v[94:95], v[94:95]
    v_pk_fma_f32 v[144:145], v[144:145], s[42:43], v[8:9]
    v_pk_fma_f32 v[146:147], v[146:147], s[42:43], v[8:9]
    v_pk_fma_f32 v[148:149], v[148:149], s[42:43], v[8:9]
    v_pk_fma_f32 v[150:151], v[150:151], s[42:43], v[8:9]
    v_pk_fma_f32 v[152:153], v[152:153], s[42:43], v[8:9]
    v_pk_fma_f32 v[154:155], v[154:155], s[42:43], v[8:9]
    v_pk_fma_f32 v[156:157], v[156:157], s[42:43], v[8:9]
    v_pk_fma_f32 v[158:159], v[158:159], s[42:43], v[8:9]
    v_pk_mul_f32 v[144:145], v[144:145], v[80:81]
    v_pk_mul_f32 v[146:147], v[146:147], v[82:83]
    v_pk_mul_f32 v[148:149], v[148:149], v[84:85]
    v_pk_mul_f32 v[150:151], v[150:151], v[86:87]
    v_pk_mul_f32 v[152:153], v[152:153], v[88:89]
    v_pk_mul_f32 v[154:155], v[154:155], v[90:91]
    v_pk_mul_f32 v[156:157], v[156:157], v[92:93]
    v_pk_mul_f32 v[158:159], v[158:159], v[94:95]
    v_exp_f32 v144, v144
    v_exp_f32 v145, v145
    v_exp_f32 v146, v146
    v_exp_f32 v147, v147
    v_exp_f32 v148, v148
    v_exp_f32 v149, v149
    v_exp_f32 v150, v150
    v_exp_f32 v151, v151
    v_exp_f32 v152, v152
    v_exp_f32 v153, v153
    v_exp_f32 v154, v154
    v_exp_f32 v155, v155
    v_exp_f32 v156, v156
    v_exp_f32 v157, v157
    v_exp_f32 v158, v158
    v_exp_f32 v159, v159
    v_pk_add_f32 v[144:145], v[144:145], 1.0 op_sel_hi:[1,0]
    v_pk_add_f32 v[146:147], v[146:147], 1.0 op_sel_hi:[1,0]
    v_pk_add_f32 v[148:149], v[148:149], 1.0 op_sel_hi:[1,0]
    v_pk_add_f32 v[150:151], v[150:151], 1.0 op_sel_hi:[1,0]
    v_pk_add_f32 v[152:153], v[152:153], 1.0 op_sel_hi:[1,0]
    v_pk_add_f32 v[154:155], v[154:155], 1.0 op_sel_hi:[1,0]
    v_pk_add_f32 v[156:157], v[156:157], 1.0 op_sel_hi:[1,0]
    v_pk_add_f32 v[158:159], v[158:159], 1.0 op_sel_hi:[1,0]
    v_rcp_f32 v144, v144
    v_rcp_f32 v145, v145
    v_rcp_f32 v146, v146
    v_rcp_f32 v147, v147
    v_rcp_f32 v148, v148
    v_rcp_f32 v149, v149
    v_rcp_f32 v150, v150
    v_rcp_f32 v151, v151
    v_rcp_f32 v152, v152
    v_rcp_f32 v153, v153
    v_rcp_f32 v154, v154
    v_rcp_f32 v155, v155
    v_rcp_f32 v156, v156
    v_rcp_f32 v157, v157
    v_rcp_f32 v158, v158
    v_rcp_f32 v159, v159
    v_pk_mul_f32 v[144:145], v[144:145], v[80:81]
    v_pk_mul_f32 v[146:147], v[146:147], v[82:83]
    v_pk_mul_f32 v[148:149], v[148:149], v[84:85]
    v_pk_mul_f32 v[150:151], v[150:151], v[86:87]
    v_pk_mul_f32 v[152:153], v[152:153], v[88:89]
    v_pk_mul_f32 v[154:155], v[154:155], v[90:91]
    v_pk_mul_f32 v[156:157], v[156:157], v[92:93]
    v_pk_mul_f32 v[158:159], v[158:159], v[94:95]
    v_cvt_pk_bf16_f32 v248, v144, v145
    v_cvt_pk_bf16_f32 v249, v146, v147
    v_cvt_pk_bf16_f32 v250, v148, v149
    v_cvt_pk_bf16_f32 v251, v150, v151
    v_cvt_pk_bf16_f32 v252, v152, v153
    v_cvt_pk_bf16_f32 v253, v154, v155
    v_cvt_pk_bf16_f32 v254, v156, v157
    v_cvt_pk_bf16_f32 v255, v158, v159
    buffer_store_dwordx4 v[248:251], v6, s[28:31], s39 offen offset:1024 sc0 sc1
    buffer_store_dwordx4 v[252:255], v6, s[28:31], s39 offen offset:1280 sc0 sc1
    s_nop 7
    s_nop 7
    v_pk_mul_f32 v[128:129], v[96:97], v[96:97]
    v_pk_mul_f32 v[130:131], v[98:99], v[98:99]
    v_pk_mul_f32 v[132:133], v[100:101], v[100:101]
    v_pk_mul_f32 v[134:135], v[102:103], v[102:103]
    v_pk_mul_f32 v[136:137], v[104:105], v[104:105]
    v_pk_mul_f32 v[138:139], v[106:107], v[106:107]
    v_pk_mul_f32 v[140:141], v[108:109], v[108:109]
    v_pk_mul_f32 v[142:143], v[110:111], v[110:111]
    v_pk_fma_f32 v[128:129], v[128:129], s[42:43], v[8:9]
    v_pk_fma_f32 v[130:131], v[130:131], s[42:43], v[8:9]
    v_pk_fma_f32 v[132:133], v[132:133], s[42:43], v[8:9]
    v_pk_fma_f32 v[134:135], v[134:135], s[42:43], v[8:9]
    v_pk_fma_f32 v[136:137], v[136:137], s[42:43], v[8:9]
    v_pk_fma_f32 v[138:139], v[138:139], s[42:43], v[8:9]
    v_pk_fma_f32 v[140:141], v[140:141], s[42:43], v[8:9]
    v_pk_fma_f32 v[142:143], v[142:143], s[42:43], v[8:9]
    v_pk_mul_f32 v[128:129], v[128:129], v[96:97]
    v_pk_mul_f32 v[130:131], v[130:131], v[98:99]
    v_pk_mul_f32 v[132:133], v[132:133], v[100:101]
    v_pk_mul_f32 v[134:135], v[134:135], v[102:103]
    v_pk_mul_f32 v[136:137], v[136:137], v[104:105]
    v_pk_mul_f32 v[138:139], v[138:139], v[106:107]
    v_pk_mul_f32 v[140:141], v[140:141], v[108:109]
    v_pk_mul_f32 v[142:143], v[142:143], v[110:111]
    v_exp_f32 v128, v128
    v_exp_f32 v129, v129
    v_exp_f32 v130, v130
    v_exp_f32 v131, v131
    v_exp_f32 v132, v132
    v_exp_f32 v133, v133
    v_exp_f32 v134, v134
    v_exp_f32 v135, v135
    v_exp_f32 v136, v136
    v_exp_f32 v137, v137
    v_exp_f32 v138, v138
    v_exp_f32 v139, v139
    v_exp_f32 v140, v140
    v_exp_f32 v141, v141
    v_exp_f32 v142, v142
    v_exp_f32 v143, v143
    v_pk_add_f32 v[128:129], v[128:129], 1.0 op_sel_hi:[1,0]
    v_pk_add_f32 v[130:131], v[130:131], 1.0 op_sel_hi:[1,0]
    v_pk_add_f32 v[132:133], v[132:133], 1.0 op_sel_hi:[1,0]
    v_pk_add_f32 v[134:135], v[134:135], 1.0 op_sel_hi:[1,0]
    v_pk_add_f32 v[136:137], v[136:137], 1.0 op_sel_hi:[1,0]
    v_pk_add_f32 v[138:139], v[138:139], 1.0 op_sel_hi:[1,0]
    v_pk_add_f32 v[140:141], v[140:141], 1.0 op_sel_hi:[1,0]
    v_pk_add_f32 v[142:143], v[142:143], 1.0 op_sel_hi:[1,0]
    v_rcp_f32 v128, v128
    v_rcp_f32 v129, v129
    v_rcp_f32 v130, v130
    v_rcp_f32 v131, v131
    v_rcp_f32 v132, v132
    v_rcp_f32 v133, v133
    v_rcp_f32 v134, v134
    v_rcp_f32 v135, v135
    v_rcp_f32 v136, v136
    v_rcp_f32 v137, v137
    v_rcp_f32 v138, v138
    v_rcp_f32 v139, v139
    v_rcp_f32 v140, v140
    v_rcp_f32 v141, v141
    v_rcp_f32 v142, v142
    v_rcp_f32 v143, v143
    v_pk_mul_f32 v[128:129], v[128:129], v[96:97]
    v_pk_mul_f32 v[130:131], v[130:131], v[98:99]
    v_pk_mul_f32 v[132:133], v[132:133], v[100:101]
    v_pk_mul_f32 v[134:135], v[134:135], v[102:103]
    v_pk_mul_f32 v[136:137], v[136:137], v[104:105]
    v_pk_mul_f32 v[138:139], v[138:139], v[106:107]
    v_pk_mul_f32 v[140:141], v[140:141], v[108:109]
    v_pk_mul_f32 v[142:143], v[142:143], v[110:111]
    v_cvt_pk_bf16_f32 v16, v128, v129
    v_cvt_pk_bf16_f32 v17, v130, v131
    v_cvt_pk_bf16_f32 v18, v132, v133
    v_cvt_pk_bf16_f32 v19, v134, v135
    v_cvt_pk_bf16_f32 v20, v136, v137
    v_cvt_pk_bf16_f32 v21, v138, v139
    v_cvt_pk_bf16_f32 v22, v140, v141
    v_cvt_pk_bf16_f32 v23, v142, v143
    buffer_store_dwordx4 v[16:19], v6, s[28:31], s38 offen offset:2048 sc0 sc1
    buffer_store_dwordx4 v[20:23], v6, s[28:31], s38 offen offset:2304 sc0 sc1
    v_pk_mul_f32 v[144:145], v[112:113], v[112:113]
    v_pk_mul_f32 v[146:147], v[114:115], v[114:115]
    v_pk_mul_f32 v[148:149], v[116:117], v[116:117]
    v_pk_mul_f32 v[150:151], v[118:119], v[118:119]
    v_pk_mul_f32 v[152:153], v[120:121], v[120:121]
    v_pk_mul_f32 v[154:155], v[122:123], v[122:123]
    v_pk_mul_f32 v[156:157], v[124:125], v[124:125]
    v_pk_mul_f32 v[158:159], v[126:127], v[126:127]
    v_pk_fma_f32 v[144:145], v[144:145], s[42:43], v[8:9]
    v_pk_fma_f32 v[146:147], v[146:147], s[42:43], v[8:9]
    v_pk_fma_f32 v[148:149], v[148:149], s[42:43], v[8:9]
    v_pk_fma_f32 v[150:151], v[150:151], s[42:43], v[8:9]
    v_pk_fma_f32 v[152:153], v[152:153], s[42:43], v[8:9]
    v_pk_fma_f32 v[154:155], v[154:155], s[42:43], v[8:9]
    v_pk_fma_f32 v[156:157], v[156:157], s[42:43], v[8:9]
    v_pk_fma_f32 v[158:159], v[158:159], s[42:43], v[8:9]
    v_pk_mul_f32 v[144:145], v[144:145], v[112:113]
    v_pk_mul_f32 v[146:147], v[146:147], v[114:115]
    v_pk_mul_f32 v[148:149], v[148:149], v[116:117]
    v_pk_mul_f32 v[150:151], v[150:151], v[118:119]
    v_pk_mul_f32 v[152:153], v[152:153], v[120:121]
    v_pk_mul_f32 v[154:155], v[154:155], v[122:123]
    v_pk_mul_f32 v[156:157], v[156:157], v[124:125]
    v_pk_mul_f32 v[158:159], v[158:159], v[126:127]
    v_exp_f32 v144, v144
    v_exp_f32 v145, v145
    v_exp_f32 v146, v146
    v_exp_f32 v147, v147
    v_exp_f32 v148, v148
    v_exp_f32 v149, v149
    v_exp_f32 v150, v150
    v_exp_f32 v151, v151
    v_exp_f32 v152, v152
    v_exp_f32 v153, v153
    v_exp_f32 v154, v154
    v_exp_f32 v155, v155
    v_exp_f32 v156, v156
    v_exp_f32 v157, v157
    v_exp_f32 v158, v158
    v_exp_f32 v159, v159
    v_pk_add_f32 v[144:145], v[144:145], 1.0 op_sel_hi:[1,0]
    v_pk_add_f32 v[146:147], v[146:147], 1.0 op_sel_hi:[1,0]
    v_pk_add_f32 v[148:149], v[148:149], 1.0 op_sel_hi:[1,0]
    v_pk_add_f32 v[150:151], v[150:151], 1.0 op_sel_hi:[1,0]
    v_pk_add_f32 v[152:153], v[152:153], 1.0 op_sel_hi:[1,0]
    v_pk_add_f32 v[154:155], v[154:155], 1.0 op_sel_hi:[1,0]
    v_pk_add_f32 v[156:157], v[156:157], 1.0 op_sel_hi:[1,0]
    v_pk_add_f32 v[158:159], v[158:159], 1.0 op_sel_hi:[1,0]
    v_rcp_f32 v144, v144
    v_rcp_f32 v145, v145
    v_rcp_f32 v146, v146
    v_rcp_f32 v147, v147
    v_rcp_f32 v148, v148
    v_rcp_f32 v149, v149
    v_rcp_f32 v150, v150
    v_rcp_f32 v151, v151
    v_rcp_f32 v152, v152
    v_rcp_f32 v153, v153
    v_rcp_f32 v154, v154
    v_rcp_f32 v155, v155
    v_rcp_f32 v156, v156
    v_rcp_f32 v157, v157
    v_rcp_f32 v158, v158
    v_rcp_f32 v159, v159
    v_pk_mul_f32 v[144:145], v[144:145], v[112:113]
    v_pk_mul_f32 v[146:147], v[146:147], v[114:115]
    v_pk_mul_f32 v[148:149], v[148:149], v[116:117]
    v_pk_mul_f32 v[150:151], v[150:151], v[118:119]
    v_pk_mul_f32 v[152:153], v[152:153], v[120:121]
    v_pk_mul_f32 v[154:155], v[154:155], v[122:123]
    v_pk_mul_f32 v[156:157], v[156:157], v[124:125]
    v_pk_mul_f32 v[158:159], v[158:159], v[126:127]
    v_cvt_pk_bf16_f32 v24, v144, v145
    v_cvt_pk_bf16_f32 v25, v146, v147
    v_cvt_pk_bf16_f32 v26, v148, v149
    v_cvt_pk_bf16_f32 v27, v150, v151
    v_cvt_pk_bf16_f32 v28, v152, v153
    v_cvt_pk_bf16_f32 v29, v154, v155
    v_cvt_pk_bf16_f32 v30, v156, v157
    v_cvt_pk_bf16_f32 v31, v158, v159
    buffer_store_dwordx4 v[24:27], v6, s[28:31], s39 offen offset:2048 sc0 sc1
    buffer_store_dwordx4 v[28:31], v6, s[28:31], s39 offen offset:2304 sc0 sc1
    s_endpgm
K2_FFT:
    s_getpc_b64 s[46:47]
CPF4:
    s_add_u32 s46, s46, K2_FFT-CPF4
    s_addc_u32 s47, s47, (K2_FFT-CPF4)>>32
    v_lshlrev_b32 v250, 6, v0
    v_add_u32 v250, 0, v250
    v_min_u32 v250, K2_SIDE-K2_FFT-4, v250
    v_mov_b32 v251, s47
    v_add_co_u32 v250, vcc, s46, v250
    v_addc_co_u32 v251, vcc, 0, v251, vcc
    global_load_dword v16, v[250:251], off
    s_sub_u32 s12, s2, 144
    s_lshr_b32 s34, s12, 2
    s_sub_u32 s35, s34, 4
    s_and_b32 s36, s35, 3
    s_add_u32 s36, s36, 1
    s_lshr_b32 s35, s35, 2
    s_cmp_lt_u32 s34, 4
    s_cselect_b32 s36, 0, s36
    s_cselect_b32 s35, s34, s35
    s_lshl_b32 s35, s35, 2
    s_and_b32 s34, s12, 3
    s_add_u32 s35, s35, s34
    s_lshl_b32 s35, s35, 2
    s_add_u32 s35, s35, s3
    s_mul_i32 s35, s35, 5
    s_add_u32 s13, s35, s36
    s_add_u32 s35, s3, 320
    s_cmp_eq_u32 s12, 80
    s_cselect_b32 s13, s35, s13
    s_lshl_b32 s14, s13, 13
    s_add_u32 s15, s14, 4096
    s_mov_b32 s33, s15
    s_cmp_eq_u32 s13, 0
    s_cselect_b32 s15, 1073741824, s15
    s_cmp_ge_u32 s13, 320
    s_cselect_b32 s15, 1073741824, s15
    v_and_b32 v3, 31, v2
    v_lshrrev_b32 v4, 5, v2
    v_lshlrev_b32 v5, 6, v3
    v_lshl_add_u32 v5, v4, 5, v5
    v_lshlrev_b32 v6, 4, v2
    s_waitcnt lgkmcnt(0)
    s_mov_b32 s16, s10
    s_mov_b32 s17, s11
    s_mov_b32 s18, 0x282000
    s_mov_b32 s19, 0x00020000
    s_add_u32 s20, s10, 0x300000
    s_addc_u32 s21, s11, 0
    s_mov_b32 s22, 0x282000
    s_mov_b32 s23, 0x00020000
    s_add_u32 s28, s10, 0x900000
    s_addc_u32 s29, s11, 0
    s_mov_b32 s30, 0x960000
    s_mov_b32 s31, 0x00020000
    buffer_load_dwordx4 a[0:3], v5, s[16:19], s14 offen offset:0
    buffer_load_dwordx4 a[16:19], v5, s[16:19], s15 offen offset:0
    buffer_load_dwordx4 a[4:7], v5, s[16:19], s14 offen offset:16
    buffer_load_dwordx4 a[20:23], v5, s[16:19], s15 offen offset:16
    buffer_load_dwordx4 a[8:11], v5, s[16:19], s14 offen offset:2048
    buffer_load_dwordx4 a[24:27], v5, s[16:19], s15 offen offset:2048
    buffer_load_dwordx4 a[12:15], v5, s[16:19], s14 offen offset:2064
    buffer_load_dwordx4 a[28:31], v5, s[16:19], s15 offen offset:2064
    v_cvt_f32_u32 v7, v3
    v_lshlrev_b32 v8, 2, v4
    v_cvt_f32_u32 v8, v8
    v_and_b32 v15, 1, v2
    v_mul_u32_u24 v15, 0x8000, v15
    v_lshl_or_b32 v15, v15, 16, v15
    v_add_f32 v9, 0x00000000, v7
    v_mul_f32 v9, 0x3d000000, v9
    v_mul_f32 v10, v9, v8
    v_fmamk_f32 v48, v9, 0x00000000, v10
    v_fmamk_f32 v49, v9, 0x3f800000, v10
    v_fmamk_f32 v50, v9, 0x40000000, v10
    v_fmamk_f32 v51, v9, 0x40400000, v10
    v_fmamk_f32 v52, v9, 0x41000000, v10
    v_fmamk_f32 v53, v9, 0x41100000, v10
    v_fmamk_f32 v54, v9, 0x41200000, v10
    v_fmamk_f32 v55, v9, 0x41300000, v10
    v_fmamk_f32 v56, v9, 0x41800000, v10
    v_fmamk_f32 v57, v9, 0x41880000, v10
    v_fmamk_f32 v58, v9, 0x41900000, v10
    v_fmamk_f32 v59, v9, 0x41980000, v10
    v_fmamk_f32 v60, v9, 0x41c00000, v10
    v_fmamk_f32 v61, v9, 0x41c80000, v10
    v_fmamk_f32 v62, v9, 0x41d00000, v10
    v_fmamk_f32 v63, v9, 0x41d80000, v10
    v_cos_f32 v64, v48
    v_sin_f32 v80, v48
    v_cos_f32 v65, v49
    v_sin_f32 v81, v49
    v_cos_f32 v66, v50
    v_sin_f32 v82, v50
    v_cos_f32 v67, v51
    v_sin_f32 v83, v51
    v_cos_f32 v68, v52
    v_sin_f32 v84, v52
    v_cos_f32 v69, v53
    v_sin_f32 v85, v53
    v_cos_f32 v70, v54
    v_sin_f32 v86, v54
    v_cos_f32 v71, v55
    v_sin_f32 v87, v55
    v_cos_f32 v72, v56
    v_sin_f32 v88, v56
    v_cos_f32 v73, v57
    v_sin_f32 v89, v57
    v_cos_f32 v74, v58
    v_sin_f32 v90, v58
    v_cos_f32 v75, v59
    v_sin_f32 v91, v59
    v_cos_f32 v76, v60
    v_sin_f32 v92, v60
    v_cos_f32 v77, v61
    v_sin_f32 v93, v61
    v_cos_f32 v78, v62
    v_sin_f32 v94, v62
    v_cos_f32 v79, v63
    v_sin_f32 v95, v63
    v_cvt_pk_bf16_f32 v112, v64, v65
    v_cvt_pk_bf16_f32 v120, v80, v81
    v_cvt_pk_bf16_f32 v128, -v80, -v81
    v_cvt_pk_bf16_f32 v113, v66, v67
    v_cvt_pk_bf16_f32 v121, v82, v83
    v_cvt_pk_bf16_f32 v129, -v82, -v83
    v_cvt_pk_bf16_f32 v114, v68, v69
    v_cvt_pk_bf16_f32 v122, v84, v85
    v_cvt_pk_bf16_f32 v130, -v84, -v85
    v_cvt_pk_bf16_f32 v115, v70, v71
    v_cvt_pk_bf16_f32 v123, v86, v87
    v_cvt_pk_bf16_f32 v131, -v86, -v87
    v_cvt_pk_bf16_f32 v116, v72, v73
    v_cvt_pk_bf16_f32 v124, v88, v89
    v_cvt_pk_bf16_f32 v132, -v88, -v89
    v_cvt_pk_bf16_f32 v117, v74, v75
    v_cvt_pk_bf16_f32 v125, v90, v91
    v_cvt_pk_bf16_f32 v133, -v90, -v91
    v_cvt_pk_bf16_f32 v118, v76, v77
    v_cvt_pk_bf16_f32 v126, v92, v93
    v_cvt_pk_bf16_f32 v134, -v92, -v93
    v_cvt_pk_bf16_f32 v119, v78, v79
    v_cvt_pk_bf16_f32 v127, v94, v95
    v_cvt_pk_bf16_f32 v135, -v94, -v95
    v_accvgpr_write_b32 a32, v112
    v_accvgpr_write_b32 a33, v113
    v_accvgpr_write_b32 a34, v114
    v_accvgpr_write_b32 a35, v115
    v_accvgpr_write_b32 a36, v116
    v_accvgpr_write_b32 a37, v117
    v_accvgpr_write_b32 a38, v118
    v_accvgpr_write_b32 a39, v119
    v_accvgpr_write_b32 a40, v120
    v_accvgpr_write_b32 a41, v121
    v_accvgpr_write_b32 a42, v122
    v_accvgpr_write_b32 a43, v123
    v_accvgpr_write_b32 a44, v124
    v_accvgpr_write_b32 a45, v125
    v_accvgpr_write_b32 a46, v126
    v_accvgpr_write_b32 a47, v127
    v_accvgpr_write_b32 a48, v128
    v_accvgpr_write_b32 a49, v129
    v_accvgpr_write_b32 a50, v130
    v_accvgpr_write_b32 a51, v131
    v_accvgpr_write_b32 a52, v132
    v_accvgpr_write_b32 a53, v133
    v_accvgpr_write_b32 a54, v134
    v_accvgpr_write_b32 a55, v135
    v_add_f32 v9, 0x00000000, v7
    v_mul_f32 v9, 0x3a000000, v9
    v_mul_f32 v10, v9, v8
    v_fmamk_f32 v48, v9, 0x00000000, v10
    v_fmamk_f32 v49, v9, 0x3f800000, v10
    v_fmamk_f32 v50, v9, 0x40000000, v10
    v_fmamk_f32 v51, v9, 0x40400000, v10
    v_fmamk_f32 v52, v9, 0x41000000, v10
    v_fmamk_f32 v53, v9, 0x41100000, v10
    v_fmamk_f32 v54, v9, 0x41200000, v10
    v_fmamk_f32 v55, v9, 0x41300000, v10
    v_fmamk_f32 v56, v9, 0x41800000, v10
    v_fmamk_f32 v57, v9, 0x41880000, v10
    v_fmamk_f32 v58, v9, 0x41900000, v10
    v_fmamk_f32 v59, v9, 0x41980000, v10
    v_fmamk_f32 v60, v9, 0x41c00000, v10
    v_fmamk_f32 v61, v9, 0x41c80000, v10
    v_fmamk_f32 v62, v9, 0x41d00000, v10
    v_fmamk_f32 v63, v9, 0x41d80000, v10
    v_cos_f32 v160, v48
    v_sin_f32 v176, v48
    v_cos_f32 v161, v49
    v_sin_f32 v177, v49
    v_cos_f32 v162, v50
    v_sin_f32 v178, v50
    v_cos_f32 v163, v51
    v_sin_f32 v179, v51
    v_cos_f32 v164, v52
    v_sin_f32 v180, v52
    v_cos_f32 v165, v53
    v_sin_f32 v181, v53
    v_cos_f32 v166, v54
    v_sin_f32 v182, v54
    v_cos_f32 v167, v55
    v_sin_f32 v183, v55
    v_cos_f32 v168, v56
    v_sin_f32 v184, v56
    v_cos_f32 v169, v57
    v_sin_f32 v185, v57
    v_cos_f32 v170, v58
    v_sin_f32 v186, v58
    v_cos_f32 v171, v59
    v_sin_f32 v187, v59
    v_cos_f32 v172, v60
    v_sin_f32 v188, v60
    v_cos_f32 v173, v61
    v_sin_f32 v189, v61
    v_cos_f32 v174, v62
    v_sin_f32 v190, v62
    v_cos_f32 v175, v63
    v_sin_f32 v191, v63
    v_add_f32 v9, 0x00000000, v7
    v_mul_f32 v9, 0x3a000000, v9
    v_mul_f32 v10, v9, v8
    v_fmamk_f32 v10, v7, 0x3c800000, v10
    v_fmamk_f32 v48, v9, 0x00000000, v10
    v_fmamk_f32 v49, v9, 0x3f800000, v10
    v_fmamk_f32 v50, v9, 0x40000000, v10
    v_fmamk_f32 v51, v9, 0x40400000, v10
    v_fmamk_f32 v52, v9, 0x41000000, v10
    v_fmamk_f32 v53, v9, 0x41100000, v10
    v_fmamk_f32 v54, v9, 0x41200000, v10
    v_fmamk_f32 v55, v9, 0x41300000, v10
    v_fmamk_f32 v56, v9, 0x41800000, v10
    v_fmamk_f32 v57, v9, 0x41880000, v10
    v_fmamk_f32 v58, v9, 0x41900000, v10
    v_fmamk_f32 v59, v9, 0x41980000, v10
    v_fmamk_f32 v60, v9, 0x41c00000, v10
    v_fmamk_f32 v61, v9, 0x41c80000, v10
    v_fmamk_f32 v62, v9, 0x41d00000, v10
    v_fmamk_f32 v63, v9, 0x41d80000, v10
    v_cos_f32 v192, v48
    v_sin_f32 v208, v48
    v_cos_f32 v193, v49
    v_sin_f32 v209, v49
    v_cos_f32 v194, v50
    v_sin_f32 v210, v50
    v_cos_f32 v195, v51
    v_sin_f32 v211, v51
    v_cos_f32 v196, v52
    v_sin_f32 v212, v52
    v_cos_f32 v197, v53
    v_sin_f32 v213, v53
    v_cos_f32 v198, v54
    v_sin_f32 v214, v54
    v_cos_f32 v199, v55
    v_sin_f32 v215, v55
    v_cos_f32 v200, v56
    v_sin_f32 v216, v56
    v_cos_f32 v201, v57
    v_sin_f32 v217, v57
    v_cos_f32 v202, v58
    v_sin_f32 v218, v58
    v_cos_f32 v203, v59
    v_sin_f32 v219, v59
    v_cos_f32 v204, v60
    v_sin_f32 v220, v60
    v_cos_f32 v205, v61
    v_sin_f32 v221, v61
    v_cos_f32 v206, v62
    v_sin_f32 v222, v62
    v_cos_f32 v207, v63
    v_sin_f32 v223, v63
    v_add_f32 v9, 0x42000000, v7
    v_mul_f32 v9, 0x3a000000, v9
    v_mul_f32 v10, v9, v8
    v_fmamk_f32 v48, v9, 0x00000000, v10
    v_fmamk_f32 v49, v9, 0x3f800000, v10
    v_fmamk_f32 v50, v9, 0x40000000, v10
    v_fmamk_f32 v51, v9, 0x40400000, v10
    v_fmamk_f32 v52, v9, 0x41000000, v10
    v_fmamk_f32 v53, v9, 0x41100000, v10
    v_fmamk_f32 v54, v9, 0x41200000, v10
    v_fmamk_f32 v55, v9, 0x41300000, v10
    v_fmamk_f32 v56, v9, 0x41800000, v10
    v_fmamk_f32 v57, v9, 0x41880000, v10
    v_fmamk_f32 v58, v9, 0x41900000, v10
    v_fmamk_f32 v59, v9, 0x41980000, v10
    v_fmamk_f32 v60, v9, 0x41c00000, v10
    v_fmamk_f32 v61, v9, 0x41c80000, v10
    v_fmamk_f32 v62, v9, 0x41d00000, v10
    v_fmamk_f32 v63, v9, 0x41d80000, v10
    v_cos_f32 v224, v48
    v_sin_f32 v240, v48
    v_cos_f32 v225, v49
    v_sin_f32 v241, v49
    v_cos_f32 v226, v50
    v_sin_f32 v242, v50
    v_cos_f32 v227, v51
    v_sin_f32 v243, v51
    v_cos_f32 v228, v52
    v_sin_f32 v244, v52
    v_cos_f32 v229, v53
    v_sin_f32 v245, v53
    v_cos_f32 v230, v54
    v_sin_f32 v246, v54
    v_cos_f32 v231, v55
    v_sin_f32 v247, v55
    v_cos_f32 v232, v56
    v_sin_f32 v248, v56
    v_cos_f32 v233, v57
    v_sin_f32 v249, v57
    v_cos_f32 v234, v58
    v_sin_f32 v250, v58
    v_cos_f32 v235, v59
    v_sin_f32 v251, v59
    v_cos_f32 v236, v60
    v_sin_f32 v252, v60
    v_cos_f32 v237, v61
    v_sin_f32 v253, v61
    v_cos_f32 v238, v62
    v_sin_f32 v254, v62
    v_cos_f32 v239, v63
    v_sin_f32 v255, v63
    v_add_f32 v9, 0x00000000, v7
    v_mul_f32 v9, 0x3c800000, v9
    v_mul_f32 v10, v9, v8
    v_fmamk_f32 v48, v9, 0x00000000, v10
    v_fmamk_f32 v49, v9, 0x3f800000, v10
    v_fmamk_f32 v50, v9, 0x40000000, v10
    v_fmamk_f32 v51, v9, 0x40400000, v10
    v_fmamk_f32 v52, v9, 0x41000000, v10
    v_fmamk_f32 v53, v9, 0x41100000, v10
    v_fmamk_f32 v54, v9, 0x41200000, v10
    v_fmamk_f32 v55, v9, 0x41300000, v10
    v_fmamk_f32 v56, v9, 0x41800000, v10
    v_fmamk_f32 v57, v9, 0x41880000, v10
    v_fmamk_f32 v58, v9, 0x41900000, v10
    v_fmamk_f32 v59, v9, 0x41980000, v10
    v_fmamk_f32 v60, v9, 0x41c00000, v10
    v_fmamk_f32 v61, v9, 0x41c80000, v10
    v_fmamk_f32 v62, v9, 0x41d00000, v10
    v_fmamk_f32 v63, v9, 0x41d80000, v10
    v_cos_f32 v64, v48
    v_sin_f32 v80, v48
    v_cos_f32 v65, v49
    v_sin_f32 v81, v49
    v_cos_f32 v66, v50
    v_sin_f32 v82, v50
    v_cos_f32 v67, v51
    v_sin_f32 v83, v51
    v_cos_f32 v68, v52
    v_sin_f32 v84, v52
    v_cos_f32 v69, v53
    v_sin_f32 v85, v53
    v_cos_f32 v70, v54
    v_sin_f32 v86, v54
    v_cos_f32 v71, v55
    v_sin_f32 v87, v55
    v_cos_f32 v72, v56
    v_sin_f32 v88, v56
    v_cos_f32 v73, v57
    v_sin_f32 v89, v57
    v_cos_f32 v74, v58
    v_sin_f32 v90, v58
    v_cos_f32 v75, v59
    v_sin_f32 v91, v59
    v_cos_f32 v76, v60
    v_sin_f32 v92, v60
    v_cos_f32 v77, v61
    v_sin_f32 v93, v61
    v_cos_f32 v78, v62
    v_sin_f32 v94, v62
    v_cos_f32 v79, v63
    v_sin_f32 v95, v63
    v_cvt_pk_bf16_f32 v112, v64, v65
    v_cvt_pk_bf16_f32 v120, v80, v81
    v_cvt_pk_bf16_f32 v113, v66, v67
    v_cvt_pk_bf16_f32 v121, v82, v83
    v_cvt_pk_bf16_f32 v114, v68, v69
    v_cvt_pk_bf16_f32 v122, v84, v85
    v_cvt_pk_bf16_f32 v115, v70, v71
    v_cvt_pk_bf16_f32 v123, v86, v87
    v_cvt_pk_bf16_f32 v116, v72, v73
    v_cvt_pk_bf16_f32 v124, v88, v89
    v_cvt_pk_bf16_f32 v117, v74, v75
    v_cvt_pk_bf16_f32 v125, v90, v91
    v_cvt_pk_bf16_f32 v118, v76, v77
    v_cvt_pk_bf16_f32 v126, v92, v93
    v_cvt_pk_bf16_f32 v119, v78, v79
    v_cvt_pk_bf16_f32 v127, v94, v95
    v_xor_b32 v11, v15, v112
    v_xor_b32 v12, 0x80000000, v112
    v_accvgpr_write_b32 a56, v112
    v_xor_b32 v13, 0x80000000, v11
    v_accvgpr_write_b32 a64, v11
    v_accvgpr_write_b32 a72, v12
    v_accvgpr_write_b32 a80, v13
    v_xor_b32 v11, v15, v113
    v_xor_b32 v12, 0x80000000, v113
    v_accvgpr_write_b32 a57, v113
    v_xor_b32 v13, 0x80000000, v11
    v_accvgpr_write_b32 a65, v11
    v_accvgpr_write_b32 a73, v12
    v_accvgpr_write_b32 a81, v13
    v_xor_b32 v11, v15, v114
    v_xor_b32 v12, 0x80000000, v114
    v_accvgpr_write_b32 a58, v114
    v_xor_b32 v13, 0x80000000, v11
    v_accvgpr_write_b32 a66, v11
    v_accvgpr_write_b32 a74, v12
    v_accvgpr_write_b32 a82, v13
    v_xor_b32 v11, v15, v115
    v_xor_b32 v12, 0x80000000, v115
    v_accvgpr_write_b32 a59, v115
    v_xor_b32 v13, 0x80000000, v11
    v_accvgpr_write_b32 a67, v11
    v_accvgpr_write_b32 a75, v12
    v_accvgpr_write_b32 a83, v13
    v_xor_b32 v11, v15, v116
    v_xor_b32 v12, 0x80000000, v116
    v_accvgpr_write_b32 a60, v116
    v_xor_b32 v13, 0x80000000, v11
    v_accvgpr_write_b32 a68, v11
    v_accvgpr_write_b32 a76, v12
    v_accvgpr_write_b32 a84, v13
    v_xor_b32 v11, v15, v117
    v_xor_b32 v12, 0x80000000, v117
    v_accvgpr_write_b32 a61, v117
    v_xor_b32 v13, 0x80000000, v11
    v_accvgpr_write_b32 a69, v11
    v_accvgpr_write_b32 a77, v12
    v_accvgpr_write_b32 a85, v13
    v_xor_b32 v11, v15, v118
    v_xor_b32 v12, 0x80000000, v118
    v_accvgpr_write_b32 a62, v118
    v_xor_b32 v13, 0x80000000, v11
    v_accvgpr_write_b32 a70, v11
    v_accvgpr_write_b32 a78, v12
    v_accvgpr_write_b32 a86, v13
    v_xor_b32 v11, v15, v119
    v_xor_b32 v12, 0x80000000, v119
    v_accvgpr_write_b32 a63, v119
    v_xor_b32 v13, 0x80000000, v11
    v_accvgpr_write_b32 a71, v11
    v_accvgpr_write_b32 a79, v12
    v_accvgpr_write_b32 a87, v13
    v_xor_b32 v11, v15, v120
    v_xor_b32 v12, 0x80000000, v120
    v_accvgpr_write_b32 a88, v120
    v_xor_b32 v13, 0x80000000, v11
    v_accvgpr_write_b32 a96, v11
    v_accvgpr_write_b32 a104, v12
    v_accvgpr_write_b32 a112, v13
    v_xor_b32 v11, v15, v121
    v_xor_b32 v12, 0x80000000, v121
    v_accvgpr_write_b32 a89, v121
    v_xor_b32 v13, 0x80000000, v11
    v_accvgpr_write_b32 a97, v11
    v_accvgpr_write_b32 a105, v12
    v_accvgpr_write_b32 a113, v13
    v_xor_b32 v11, v15, v122
    v_xor_b32 v12, 0x80000000, v122
    v_accvgpr_write_b32 a90, v122
    v_xor_b32 v13, 0x80000000, v11
    v_accvgpr_write_b32 a98, v11
    v_accvgpr_write_b32 a106, v12
    v_accvgpr_write_b32 a114, v13
    v_xor_b32 v11, v15, v123
    v_xor_b32 v12, 0x80000000, v123
    v_accvgpr_write_b32 a91, v123
    v_xor_b32 v13, 0x80000000, v11
    v_accvgpr_write_b32 a99, v11
    v_accvgpr_write_b32 a107, v12
    v_accvgpr_write_b32 a115, v13
    v_xor_b32 v11, v15, v124
    v_xor_b32 v12, 0x80000000, v124
    v_accvgpr_write_b32 a92, v124
    v_xor_b32 v13, 0x80000000, v11
    v_accvgpr_write_b32 a100, v11
    v_accvgpr_write_b32 a108, v12
    v_accvgpr_write_b32 a116, v13
    v_xor_b32 v11, v15, v125
    v_xor_b32 v12, 0x80000000, v125
    v_accvgpr_write_b32 a93, v125
    v_xor_b32 v13, 0x80000000, v11
    v_accvgpr_write_b32 a101, v11
    v_accvgpr_write_b32 a109, v12
    v_accvgpr_write_b32 a117, v13
    v_xor_b32 v11, v15, v126
    v_xor_b32 v12, 0x80000000, v126
    v_accvgpr_write_b32 a94, v126
    v_xor_b32 v13, 0x80000000, v11
    v_accvgpr_write_b32 a102, v11
    v_accvgpr_write_b32 a110, v12
    v_accvgpr_write_b32 a118, v13
    v_xor_b32 v11, v15, v127
    v_xor_b32 v12, 0x80000000, v127
    v_accvgpr_write_b32 a95, v127
    v_xor_b32 v13, 0x80000000, v11
    v_accvgpr_write_b32 a103, v11
    v_accvgpr_write_b32 a111, v12
    v_accvgpr_write_b32 a119, v13
    buffer_load_dwordx4 v[16:19], v6, s[20:23], s14 offen offset:0
    buffer_load_dwordx4 v[20:23], v6, s[20:23], s14 offen offset:1024
    buffer_load_dwordx4 v[24:27], v6, s[20:23], s14 offen offset:2048
    buffer_load_dwordx4 v[28:31], v6, s[20:23], s14 offen offset:3072
    buffer_load_dwordx4 v[32:35], v6, s[20:23], s33 offen offset:0
    buffer_load_dwordx4 v[36:39], v6, s[20:23], s33 offen offset:1024
    buffer_load_dwordx4 v[40:43], v6, s[20:23], s33 offen offset:2048
    buffer_load_dwordx4 v[44:47], v6, s[20:23], s33 offen offset:3072
    s_waitcnt vmcnt(8)
    v_mfma_f32_32x32x16_bf16 v[48:63], a[0:3], a[32:35], 0
    v_mfma_f32_32x32x16_bf16 v[48:63], a[4:7], a[36:39], v[48:63]
    v_mfma_f32_32x32x16_bf16 v[48:63], a[16:19], a[40:43], v[48:63]
    v_mfma_f32_32x32x16_bf16 v[48:63], a[20:23], a[44:47], v[48:63]
    v_mfma_f32_32x32x16_bf16 v[64:79], a[16:19], a[32:35], 0
    v_mfma_f32_32x32x16_bf16 v[64:79], a[20:23], a[36:39], v[64:79]
    v_mfma_f32_32x32x16_bf16 v[64:79], a[0:3], a[48:51], v[64:79]
    v_mfma_f32_32x32x16_bf16 v[64:79], a[4:7], a[52:55], v[64:79]
    v_mfma_f32_32x32x16_bf16 v[80:95], a[8:11], a[32:35], 0
    v_mfma_f32_32x32x16_bf16 v[80:95], a[12:15], a[36:39], v[80:95]
    v_mfma_f32_32x32x16_bf16 v[80:95], a[24:27], a[40:43], v[80:95]
    v_mfma_f32_32x32x16_bf16 v[80:95], a[28:31], a[44:47], v[80:95]
    v_mfma_f32_32x32x16_bf16 v[96:111], a[24:27], a[32:35], 0
    v_mfma_f32_32x32x16_bf16 v[96:111], a[28:31], a[36:39], v[96:111]
    v_mfma_f32_32x32x16_bf16 v[96:111], a[8:11], a[48:51], v[96:111]
    v_mfma_f32_32x32x16_bf16 v[96:111], a[12:15], a[52:55], v[96:111]
    s_nop 7
    v_mul_f32 v8, v64, v176
    v_mul_f32 v12, v48, v176
    v_mul_f32 v9, v65, v177
    v_mul_f32 v13, v49, v177
    v_mul_f32 v10, v66, v178
    v_mul_f32 v14, v50, v178
    v_mul_f32 v11, v67, v179
    v_mul_f32 v15, v51, v179
    v_fma_f32 v48, v48, v160, v8
    v_fma_f32 v64, v64, v160, -v12
    v_fma_f32 v49, v49, v161, v9
    v_fma_f32 v65, v65, v161, -v13
    v_fma_f32 v50, v50, v162, v10
    v_fma_f32 v66, v66, v162, -v14
    v_fma_f32 v51, v51, v163, v11
    v_fma_f32 v67, v67, v163, -v15
    v_mul_f32 v8, v68, v180
    v_mul_f32 v12, v52, v180
    v_mul_f32 v9, v69, v181
    v_mul_f32 v13, v53, v181
    v_mul_f32 v10, v70, v182
    v_mul_f32 v14, v54, v182
    v_mul_f32 v11, v71, v183
    v_mul_f32 v15, v55, v183
    v_fma_f32 v52, v52, v164, v8
    v_fma_f32 v68, v68, v164, -v12
    v_fma_f32 v53, v53, v165, v9
    v_fma_f32 v69, v69, v165, -v13
    v_fma_f32 v54, v54, v166, v10
    v_fma_f32 v70, v70, v166, -v14
    v_fma_f32 v55, v55, v167, v11
    v_fma_f32 v71, v71, v167, -v15
    v_mul_f32 v8, v72, v184
    v_mul_f32 v12, v56, v184
    v_mul_f32 v9, v73, v185
    v_mul_f32 v13, v57, v185
    v_mul_f32 v10, v74, v186
    v_mul_f32 v14, v58, v186
    v_mul_f32 v11, v75, v187
    v_mul_f32 v15, v59, v187
    v_fma_f32 v56, v56, v168, v8
    v_fma_f32 v72, v72, v168, -v12
    v_fma_f32 v57, v57, v169, v9
    v_fma_f32 v73, v73, v169, -v13
    v_fma_f32 v58, v58, v170, v10
    v_fma_f32 v74, v74, v170, -v14
    v_fma_f32 v59, v59, v171, v11
    v_fma_f32 v75, v75, v171, -v15
    v_mul_f32 v8, v76, v188
    v_mul_f32 v12, v60, v188
    v_mul_f32 v9, v77, v189
    v_mul_f32 v13, v61, v189
    v_mul_f32 v10, v78, v190
    v_mul_f32 v14, v62, v190
    v_mul_f32 v11, v79, v191
    v_mul_f32 v15, v63, v191
    v_fma_f32 v60, v60, v172, v8
    v_fma_f32 v76, v76, v172, -v12
    v_fma_f32 v61, v61, v173, v9
    v_fma_f32 v77, v77, v173, -v13
    v_fma_f32 v62, v62, v174, v10
    v_fma_f32 v78, v78, v174, -v14
    v_fma_f32 v63, v63, v175, v11
    v_fma_f32 v79, v79, v175, -v15
    v_cvt_pk_bf16_f32 v112, v48, v49
    v_cvt_pk_bf16_f32 v128, v64, v65
    v_cvt_pk_bf16_f32 v144, -v48, -v49
    v_cvt_pk_bf16_f32 v113, v50, v51
    v_cvt_pk_bf16_f32 v129, v66, v67
    v_cvt_pk_bf16_f32 v145, -v50, -v51
    v_cvt_pk_bf16_f32 v114, v52, v53
    v_cvt_pk_bf16_f32 v130, v68, v69
    v_cvt_pk_bf16_f32 v146, -v52, -v53
    v_cvt_pk_bf16_f32 v115, v54, v55
    v_cvt_pk_bf16_f32 v131, v70, v71
    v_cvt_pk_bf16_f32 v147, -v54, -v55
    v_cvt_pk_bf16_f32 v116, v56, v57
    v_cvt_pk_bf16_f32 v132, v72, v73
    v_cvt_pk_bf16_f32 v148, -v56, -v57
    v_cvt_pk_bf16_f32 v117, v58, v59
    v_cvt_pk_bf16_f32 v133, v74, v75
    v_cvt_pk_bf16_f32 v149, -v58, -v59
    v_cvt_pk_bf16_f32 v118, v60, v61
    v_cvt_pk_bf16_f32 v134, v76, v77
    v_cvt_pk_bf16_f32 v150, -v60, -v61
    v_cvt_pk_bf16_f32 v119, v62, v63
    v_cvt_pk_bf16_f32 v135, v78, v79
    v_cvt_pk_bf16_f32 v151, -v62, -v63
    s_nop 3
    v_mul_f32 v8, v96, v208
    v_mul_f32 v12, v80, v208
    v_mul_f32 v9, v97, v209
    v_mul_f32 v13, v81, v209
    v_mul_f32 v10, v98, v210
    v_mul_f32 v14, v82, v210
    v_mul_f32 v11, v99, v211
    v_mul_f32 v15, v83, v211
    v_fma_f32 v80, v80, v192, v8
    v_fma_f32 v96, v96, v192, -v12
    v_fma_f32 v81, v81, v193, v9
    v_fma_f32 v97, v97, v193, -v13
    v_fma_f32 v82, v82, v194, v10
    v_fma_f32 v98, v98, v194, -v14
    v_fma_f32 v83, v83, v195, v11
    v_fma_f32 v99, v99, v195, -v15
    v_mul_f32 v8, v100, v212
    v_mul_f32 v12, v84, v212
    v_mul_f32 v9, v101, v213
    v_mul_f32 v13, v85, v213
    v_mul_f32 v10, v102, v214
    v_mul_f32 v14, v86, v214
    v_mul_f32 v11, v103, v215
    v_mul_f32 v15, v87, v215
    v_fma_f32 v84, v84, v196, v8
    v_fma_f32 v100, v100, v196, -v12
    v_fma_f32 v85, v85, v197, v9
    v_fma_f32 v101, v101, v197, -v13
    v_fma_f32 v86, v86, v198, v10
    v_fma_f32 v102, v102, v198, -v14
    v_fma_f32 v87, v87, v199, v11
    v_fma_f32 v103, v103, v199, -v15
    v_mul_f32 v8, v104, v216
    v_mul_f32 v12, v88, v216
    v_mul_f32 v9, v105, v217
    v_mul_f32 v13, v89, v217
    v_mul_f32 v10, v106, v218
    v_mul_f32 v14, v90, v218
    v_mul_f32 v11, v107, v219
    v_mul_f32 v15, v91, v219
    v_fma_f32 v88, v88, v200, v8
    v_fma_f32 v104, v104, v200, -v12
    v_fma_f32 v89, v89, v201, v9
    v_fma_f32 v105, v105, v201, -v13
    v_fma_f32 v90, v90, v202, v10
    v_fma_f32 v106, v106, v202, -v14
    v_fma_f32 v91, v91, v203, v11
    v_fma_f32 v107, v107, v203, -v15
    v_mul_f32 v8, v108, v220
    v_mul_f32 v12, v92, v220
    v_mul_f32 v9, v109, v221
    v_mul_f32 v13, v93, v221
    v_mul_f32 v10, v110, v222
    v_mul_f32 v14, v94, v222
    v_mul_f32 v11, v111, v223
    v_mul_f32 v15, v95, v223
    v_fma_f32 v92, v92, v204, v8
    v_fma_f32 v108, v108, v204, -v12
    v_fma_f32 v93, v93, v205, v9
    v_fma_f32 v109, v109, v205, -v13
    v_fma_f32 v94, v94, v206, v10
    v_fma_f32 v110, v110, v206, -v14
    v_fma_f32 v95, v95, v207, v11
    v_fma_f32 v111, v111, v207, -v15
    v_cvt_pk_bf16_f32 v120, v80, v81
    v_cvt_pk_bf16_f32 v136, v96, v97
    v_cvt_pk_bf16_f32 v152, -v80, -v81
    v_cvt_pk_bf16_f32 v121, v82, v83
    v_cvt_pk_bf16_f32 v137, v98, v99
    v_cvt_pk_bf16_f32 v153, -v82, -v83
    v_cvt_pk_bf16_f32 v122, v84, v85
    v_cvt_pk_bf16_f32 v138, v100, v101
    v_cvt_pk_bf16_f32 v154, -v84, -v85
    v_cvt_pk_bf16_f32 v123, v86, v87
    v_cvt_pk_bf16_f32 v139, v102, v103
    v_cvt_pk_bf16_f32 v155, -v86, -v87
    v_cvt_pk_bf16_f32 v124, v88, v89
    v_cvt_pk_bf16_f32 v140, v104, v105
    v_cvt_pk_bf16_f32 v156, -v88, -v89
    v_cvt_pk_bf16_f32 v125, v90, v91
    v_cvt_pk_bf16_f32 v141, v106, v107
    v_cvt_pk_bf16_f32 v157, -v90, -v91
    v_cvt_pk_bf16_f32 v126, v92, v93
    v_cvt_pk_bf16_f32 v142, v108, v109
    v_cvt_pk_bf16_f32 v158, -v92, -v93
    v_cvt_pk_bf16_f32 v127, v94, v95
    v_cvt_pk_bf16_f32 v143, v110, v111
    v_cvt_pk_bf16_f32 v159, -v94, -v95
    s_nop 1
    v_mfma_f32_32x32x16_bf16 v[48:63], a[56:59], v[112:115], 0
    v_mfma_f32_32x32x16_bf16 v[48:63], a[60:63], v[116:119], v[48:63]
    v_mfma_f32_32x32x16_bf16 v[48:63], a[64:67], v[120:123], v[48:63]
    v_mfma_f32_32x32x16_bf16 v[48:63], a[68:71], v[124:127], v[48:63]
    v_mfma_f32_32x32x16_bf16 v[48:63], a[88:91], v[128:131], v[48:63]
    v_mfma_f32_32x32x16_bf16 v[48:63], a[92:95], v[132:135], v[48:63]
    v_mfma_f32_32x32x16_bf16 v[48:63], a[96:99], v[136:139], v[48:63]
    v_mfma_f32_32x32x16_bf16 v[48:63], a[100:103], v[140:143], v[48:63]
    v_mfma_f32_32x32x16_bf16 v[64:79], a[56:59], v[128:131], 0
    v_mfma_f32_32x32x16_bf16 v[64:79], a[60:63], v[132:135], v[64:79]
    v_mfma_f32_32x32x16_bf16 v[64:79], a[64:67], v[136:139], v[64:79]
    v_mfma_f32_32x32x16_bf16 v[64:79], a[68:71], v[140:143], v[64:79]
    v_mfma_f32_32x32x16_bf16 v[64:79], a[88:91], v[144:147], v[64:79]
    v_mfma_f32_32x32x16_bf16 v[64:79], a[92:95], v[148:151], v[64:79]
    v_mfma_f32_32x32x16_bf16 v[64:79], a[96:99], v[152:155], v[64:79]
    v_mfma_f32_32x32x16_bf16 v[64:79], a[100:103], v[156:159], v[64:79]
    v_mfma_f32_32x32x16_bf16 v[80:95], a[72:75], v[112:115], 0
    v_mfma_f32_32x32x16_bf16 v[80:95], a[76:79], v[116:119], v[80:95]
    v_mfma_f32_32x32x16_bf16 v[80:95], a[80:83], v[120:123], v[80:95]
    v_mfma_f32_32x32x16_bf16 v[80:95], a[84:87], v[124:127], v[80:95]
    v_mfma_f32_32x32x16_bf16 v[80:95], a[104:107], v[128:131], v[80:95]
    v_mfma_f32_32x32x16_bf16 v[80:95], a[108:111], v[132:135], v[80:95]
    v_mfma_f32_32x32x16_bf16 v[80:95], a[112:115], v[136:139], v[80:95]
    v_mfma_f32_32x32x16_bf16 v[80:95], a[116:119], v[140:143], v[80:95]
    v_mfma_f32_32x32x16_bf16 v[96:111], a[72:75], v[128:131], 0
    v_mfma_f32_32x32x16_bf16 v[96:111], a[76:79], v[132:135], v[96:111]
    v_mfma_f32_32x32x16_bf16 v[96:111], a[80:83], v[136:139], v[96:111]
    v_mfma_f32_32x32x16_bf16 v[96:111], a[84:87], v[140:143], v[96:111]
    v_mfma_f32_32x32x16_bf16 v[96:111], a[104:107], v[144:147], v[96:111]
    v_mfma_f32_32x32x16_bf16 v[96:111], a[108:111], v[148:151], v[96:111]
    v_mfma_f32_32x32x16_bf16 v[96:111], a[112:115], v[152:155], v[96:111]
    v_mfma_f32_32x32x16_bf16 v[96:111], a[116:119], v[156:159], v[96:111]
    s_waitcnt vmcnt(0)
    s_nop 7
    s_nop 3
    v_lshlrev_b32 v192, 16, v16
    v_and_b32 v196, 0xffff0000, v16
    v_lshlrev_b32 v193, 16, v17
    v_and_b32 v197, 0xffff0000, v17
    v_lshlrev_b32 v194, 16, v18
    v_and_b32 v198, 0xffff0000, v18
    v_lshlrev_b32 v195, 16, v19
    v_and_b32 v199, 0xffff0000, v19
    v_mul_f32 v8, v64, v196
    v_mul_f32 v12, v48, v196
    v_mul_f32 v9, v65, v197
    v_mul_f32 v13, v49, v197
    v_mul_f32 v10, v66, v198
    v_mul_f32 v14, v50, v198
    v_mul_f32 v11, v67, v199
    v_mul_f32 v15, v51, v199
    v_fma_f32 v48, v48, v192, -v8
    v_fma_f32 v64, v64, v192, v12
    v_fma_f32 v49, v49, v193, -v9
    v_fma_f32 v65, v65, v193, v13
    v_fma_f32 v50, v50, v194, -v10
    v_fma_f32 v66, v66, v194, v14
    v_fma_f32 v51, v51, v195, -v11
    v_fma_f32 v67, v67, v195, v15
    v_lshlrev_b32 v192, 16, v20
    v_and_b32 v196, 0xffff0000, v20
    v_lshlrev_b32 v193, 16, v21
    v_and_b32 v197, 0xffff0000, v21
    v_lshlrev_b32 v194, 16, v22
    v_and_b32 v198, 0xffff0000, v22
    v_lshlrev_b32 v195, 16, v23
    v_and_b32 v199, 0xffff0000, v23
    v_mul_f32 v8, v68, v196
    v_mul_f32 v12, v52, v196
    v_mul_f32 v9, v69, v197
    v_mul_f32 v13, v53, v197
    v_mul_f32 v10, v70, v198
    v_mul_f32 v14, v54, v198
    v_mul_f32 v11, v71, v199
    v_mul_f32 v15, v55, v199
    v_fma_f32 v52, v52, v192, -v8
    v_fma_f32 v68, v68, v192, v12
    v_fma_f32 v53, v53, v193, -v9
    v_fma_f32 v69, v69, v193, v13
    v_fma_f32 v54, v54, v194, -v10
    v_fma_f32 v70, v70, v194, v14
    v_fma_f32 v55, v55, v195, -v11
    v_fma_f32 v71, v71, v195, v15
    v_lshlrev_b32 v192, 16, v24
    v_and_b32 v196, 0xffff0000, v24
    v_lshlrev_b32 v193, 16, v25
    v_and_b32 v197, 0xffff0000, v25
    v_lshlrev_b32 v194, 16, v26
    v_and_b32 v198, 0xffff0000, v26
    v_lshlrev_b32 v195, 16, v27
    v_and_b32 v199, 0xffff0000, v27
    v_mul_f32 v8, v72, v196
    v_mul_f32 v12, v56, v196
    v_mul_f32 v9, v73, v197
    v_mul_f32 v13, v57, v197
    v_mul_f32 v10, v74, v198
    v_mul_f32 v14, v58, v198
    v_mul_f32 v11, v75, v199
    v_mul_f32 v15, v59, v199
    v_fma_f32 v56, v56, v192, -v8
    v_fma_f32 v72, v72, v192, v12
    v_fma_f32 v57, v57, v193, -v9
    v_fma_f32 v73, v73, v193, v13
    v_fma_f32 v58, v58, v194, -v10
    v_fma_f32 v74, v74, v194, v14
    v_fma_f32 v59, v59, v195, -v11
    v_fma_f32 v75, v75, v195, v15
    v_lshlrev_b32 v192, 16, v28
    v_and_b32 v196, 0xffff0000, v28
    v_lshlrev_b32 v193, 16, v29
    v_and_b32 v197, 0xffff0000, v29
    v_lshlrev_b32 v194, 16, v30
    v_and_b32 v198, 0xffff0000, v30
    v_lshlrev_b32 v195, 16, v31
    v_and_b32 v199, 0xffff0000, v31
    v_mul_f32 v8, v76, v196
    v_mul_f32 v12, v60, v196
    v_mul_f32 v9, v77, v197
    v_mul_f32 v13, v61, v197
    v_mul_f32 v10, v78, v198
    v_mul_f32 v14, v62, v198
    v_mul_f32 v11, v79, v199
    v_mul_f32 v15, v63, v199
    v_fma_f32 v60, v60, v192, -v8
    v_fma_f32 v76, v76, v192, v12
    v_fma_f32 v61, v61, v193, -v9
    v_fma_f32 v77, v77, v193, v13
    v_fma_f32 v62, v62, v194, -v10
    v_fma_f32 v78, v78, v194, v14
    v_fma_f32 v63, v63, v195, -v11
    v_fma_f32 v79, v79, v195, v15
    v_cvt_pk_bf16_f32 v112, v48, v49
    v_cvt_pk_bf16_f32 v128, v64, v65
    v_cvt_pk_bf16_f32 v144, -v64, -v65
    v_cvt_pk_bf16_f32 v113, v50, v51
    v_cvt_pk_bf16_f32 v129, v66, v67
    v_cvt_pk_bf16_f32 v145, -v66, -v67
    v_cvt_pk_bf16_f32 v114, v52, v53
    v_cvt_pk_bf16_f32 v130, v68, v69
    v_cvt_pk_bf16_f32 v146, -v68, -v69
    v_cvt_pk_bf16_f32 v115, v54, v55
    v_cvt_pk_bf16_f32 v131, v70, v71
    v_cvt_pk_bf16_f32 v147, -v70, -v71
    v_cvt_pk_bf16_f32 v116, v56, v57
    v_cvt_pk_bf16_f32 v132, v72, v73
    v_cvt_pk_bf16_f32 v148, -v72, -v73
    v_cvt_pk_bf16_f32 v117, v58, v59
    v_cvt_pk_bf16_f32 v133, v74, v75
    v_cvt_pk_bf16_f32 v149, -v74, -v75
    v_cvt_pk_bf16_f32 v118, v60, v61
    v_cvt_pk_bf16_f32 v134, v76, v77
    v_cvt_pk_bf16_f32 v150, -v76, -v77
    v_cvt_pk_bf16_f32 v119, v62, v63
    v_cvt_pk_bf16_f32 v135, v78, v79
    v_cvt_pk_bf16_f32 v151, -v78, -v79
    v_lshlrev_b32 v192, 16, v32
    v_and_b32 v196, 0xffff0000, v32
    v_lshlrev_b32 v193, 16, v33
    v_and_b32 v197, 0xffff0000, v33
    v_lshlrev_b32 v194, 16, v34
    v_and_b32 v198, 0xffff0000, v34
    v_lshlrev_b32 v195, 16, v35
    v_and_b32 v199, 0xffff0000, v35
    v_mul_f32 v8, v96, v196
    v_mul_f32 v12, v80, v196
    v_mul_f32 v9, v97, v197
    v_mul_f32 v13, v81, v197
    v_mul_f32 v10, v98, v198
    v_mul_f32 v14, v82, v198
    v_mul_f32 v11, v99, v199
    v_mul_f32 v15, v83, v199
    v_fma_f32 v80, v80, v192, -v8
    v_fma_f32 v96, v96, v192, v12
    v_fma_f32 v81, v81, v193, -v9
    v_fma_f32 v97, v97, v193, v13
    v_fma_f32 v82, v82, v194, -v10
    v_fma_f32 v98, v98, v194, v14
    v_fma_f32 v83, v83, v195, -v11
    v_fma_f32 v99, v99, v195, v15
    v_lshlrev_b32 v192, 16, v36
    v_and_b32 v196, 0xffff0000, v36
    v_lshlrev_b32 v193, 16, v37
    v_and_b32 v197, 0xffff0000, v37
    v_lshlrev_b32 v194, 16, v38
    v_and_b32 v198, 0xffff0000, v38
    v_lshlrev_b32 v195, 16, v39
    v_and_b32 v199, 0xffff0000, v39
    v_mul_f32 v8, v100, v196
    v_mul_f32 v12, v84, v196
    v_mul_f32 v9, v101, v197
    v_mul_f32 v13, v85, v197
    v_mul_f32 v10, v102, v198
    v_mul_f32 v14, v86, v198
    v_mul_f32 v11, v103, v199
    v_mul_f32 v15, v87, v199
    v_fma_f32 v84, v84, v192, -v8
    v_fma_f32 v100, v100, v192, v12
    v_fma_f32 v85, v85, v193, -v9
    v_fma_f32 v101, v101, v193, v13
    v_fma_f32 v86, v86, v194, -v10
    v_fma_f32 v102, v102, v194, v14
    v_fma_f32 v87, v87, v195, -v11
    v_fma_f32 v103, v103, v195, v15
    v_lshlrev_b32 v192, 16, v40
    v_and_b32 v196, 0xffff0000, v40
    v_lshlrev_b32 v193, 16, v41
    v_and_b32 v197, 0xffff0000, v41
    v_lshlrev_b32 v194, 16, v42
    v_and_b32 v198, 0xffff0000, v42
    v_lshlrev_b32 v195, 16, v43
    v_and_b32 v199, 0xffff0000, v43
    v_mul_f32 v8, v104, v196
    v_mul_f32 v12, v88, v196
    v_mul_f32 v9, v105, v197
    v_mul_f32 v13, v89, v197
    v_mul_f32 v10, v106, v198
    v_mul_f32 v14, v90, v198
    v_mul_f32 v11, v107, v199
    v_mul_f32 v15, v91, v199
    v_fma_f32 v88, v88, v192, -v8
    v_fma_f32 v104, v104, v192, v12
    v_fma_f32 v89, v89, v193, -v9
    v_fma_f32 v105, v105, v193, v13
    v_fma_f32 v90, v90, v194, -v10
    v_fma_f32 v106, v106, v194, v14
    v_fma_f32 v91, v91, v195, -v11
    v_fma_f32 v107, v107, v195, v15
    v_lshlrev_b32 v192, 16, v44
    v_and_b32 v196, 0xffff0000, v44
    v_lshlrev_b32 v193, 16, v45
    v_and_b32 v197, 0xffff0000, v45
    v_lshlrev_b32 v194, 16, v46
    v_and_b32 v198, 0xffff0000, v46
    v_lshlrev_b32 v195, 16, v47
    v_and_b32 v199, 0xffff0000, v47
    v_mul_f32 v8, v108, v196
    v_mul_f32 v12, v92, v196
    v_mul_f32 v9, v109, v197
    v_mul_f32 v13, v93, v197
    v_mul_f32 v10, v110, v198
    v_mul_f32 v14, v94, v198
    v_mul_f32 v11, v111, v199
    v_mul_f32 v15, v95, v199
    v_fma_f32 v92, v92, v192, -v8
    v_fma_f32 v108, v108, v192, v12
    v_fma_f32 v93, v93, v193, -v9
    v_fma_f32 v109, v109, v193, v13
    v_fma_f32 v94, v94, v194, -v10
    v_fma_f32 v110, v110, v194, v14
    v_fma_f32 v95, v95, v195, -v11
    v_fma_f32 v111, v111, v195, v15
    v_cvt_pk_bf16_f32 v120, v80, v81
    v_cvt_pk_bf16_f32 v136, v96, v97
    v_cvt_pk_bf16_f32 v152, -v96, -v97
    v_cvt_pk_bf16_f32 v121, v82, v83
    v_cvt_pk_bf16_f32 v137, v98, v99
    v_cvt_pk_bf16_f32 v153, -v98, -v99
    v_cvt_pk_bf16_f32 v122, v84, v85
    v_cvt_pk_bf16_f32 v138, v100, v101
    v_cvt_pk_bf16_f32 v154, -v100, -v101
    v_cvt_pk_bf16_f32 v123, v86, v87
    v_cvt_pk_bf16_f32 v139, v102, v103
    v_cvt_pk_bf16_f32 v155, -v102, -v103
    v_cvt_pk_bf16_f32 v124, v88, v89
    v_cvt_pk_bf16_f32 v140, v104, v105
    v_cvt_pk_bf16_f32 v156, -v104, -v105
    v_cvt_pk_bf16_f32 v125, v90, v91
    v_cvt_pk_bf16_f32 v141, v106, v107
    v_cvt_pk_bf16_f32 v157, -v106, -v107
    v_cvt_pk_bf16_f32 v126, v92, v93
    v_cvt_pk_bf16_f32 v142, v108, v109
    v_cvt_pk_bf16_f32 v158, -v108, -v109
    v_cvt_pk_bf16_f32 v127, v94, v95
    v_cvt_pk_bf16_f32 v143, v110, v111
    v_cvt_pk_bf16_f32 v159, -v110, -v111
    s_nop 1
    v_mfma_f32_32x32x16_bf16 v[48:63], v[112:115], a[56:59], 0
    v_mfma_f32_32x32x16_bf16 v[48:63], v[116:119], a[60:63], v[48:63]
    v_mfma_f32_32x32x16_bf16 v[48:63], v[120:123], a[64:67], v[48:63]
    v_mfma_f32_32x32x16_bf16 v[48:63], v[124:127], a[68:71], v[48:63]
    v_mfma_f32_32x32x16_bf16 v[48:63], v[144:147], a[88:91], v[48:63]
    v_mfma_f32_32x32x16_bf16 v[48:63], v[148:151], a[92:95], v[48:63]
    v_mfma_f32_32x32x16_bf16 v[48:63], v[152:155], a[96:99], v[48:63]
    v_mfma_f32_32x32x16_bf16 v[48:63], v[156:159], a[100:103], v[48:63]
    v_mfma_f32_32x32x16_bf16 v[64:79], v[128:131], a[56:59], 0
    v_mfma_f32_32x32x16_bf16 v[64:79], v[132:135], a[60:63], v[64:79]
    v_mfma_f32_32x32x16_bf16 v[64:79], v[136:139], a[64:67], v[64:79]
    v_mfma_f32_32x32x16_bf16 v[64:79], v[140:143], a[68:71], v[64:79]
    v_mfma_f32_32x32x16_bf16 v[64:79], v[112:115], a[88:91], v[64:79]
    v_mfma_f32_32x32x16_bf16 v[64:79], v[116:119], a[92:95], v[64:79]
    v_mfma_f32_32x32x16_bf16 v[64:79], v[120:123], a[96:99], v[64:79]
    v_mfma_f32_32x32x16_bf16 v[64:79], v[124:127], a[100:103], v[64:79]
    v_mfma_f32_32x32x16_bf16 v[80:95], v[112:115], a[72:75], 0
    v_mfma_f32_32x32x16_bf16 v[80:95], v[116:119], a[76:79], v[80:95]
    v_mfma_f32_32x32x16_bf16 v[80:95], v[120:123], a[80:83], v[80:95]
    v_mfma_f32_32x32x16_bf16 v[80:95], v[124:127], a[84:87], v[80:95]
    v_mfma_f32_32x32x16_bf16 v[80:95], v[144:147], a[104:107], v[80:95]
    v_mfma_f32_32x32x16_bf16 v[80:95], v[148:151], a[108:111], v[80:95]
    v_mfma_f32_32x32x16_bf16 v[80:95], v[152:155], a[112:115], v[80:95]
    v_mfma_f32_32x32x16_bf16 v[80:95], v[156:159], a[116:119], v[80:95]
    v_mfma_f32_32x32x16_bf16 v[96:111], v[128:131], a[72:75], 0
    v_mfma_f32_32x32x16_bf16 v[96:111], v[132:135], a[76:79], v[96:111]
    v_mfma_f32_32x32x16_bf16 v[96:111], v[136:139], a[80:83], v[96:111]
    v_mfma_f32_32x32x16_bf16 v[96:111], v[140:143], a[84:87], v[96:111]
    v_mfma_f32_32x32x16_bf16 v[96:111], v[112:115], a[104:107], v[96:111]
    v_mfma_f32_32x32x16_bf16 v[96:111], v[116:119], a[108:111], v[96:111]
    v_mfma_f32_32x32x16_bf16 v[96:111], v[120:123], a[112:115], v[96:111]
    v_mfma_f32_32x32x16_bf16 v[96:111], v[124:127], a[116:119], v[96:111]
    s_nop 7
    s_nop 3
    v_mul_f32 v8, v64, v176
    v_mul_f32 v12, v48, v176
    v_mul_f32 v9, v65, v177
    v_mul_f32 v13, v49, v177
    v_mul_f32 v10, v66, v178
    v_mul_f32 v14, v50, v178
    v_mul_f32 v11, v67, v179
    v_mul_f32 v15, v51, v179
    v_fma_f32 v48, v48, v160, -v8
    v_fma_f32 v64, v64, v160, v12
    v_fma_f32 v49, v49, v161, -v9
    v_fma_f32 v65, v65, v161, v13
    v_fma_f32 v50, v50, v162, -v10
    v_fma_f32 v66, v66, v162, v14
    v_fma_f32 v51, v51, v163, -v11
    v_fma_f32 v67, v67, v163, v15
    v_mul_f32 v8, v68, v180
    v_mul_f32 v12, v52, v180
    v_mul_f32 v9, v69, v181
    v_mul_f32 v13, v53, v181
    v_mul_f32 v10, v70, v182
    v_mul_f32 v14, v54, v182
    v_mul_f32 v11, v71, v183
    v_mul_f32 v15, v55, v183
    v_fma_f32 v52, v52, v164, -v8
    v_fma_f32 v68, v68, v164, v12
    v_fma_f32 v53, v53, v165, -v9
    v_fma_f32 v69, v69, v165, v13
    v_fma_f32 v54, v54, v166, -v10
    v_fma_f32 v70, v70, v166, v14
    v_fma_f32 v55, v55, v167, -v11
    v_fma_f32 v71, v71, v167, v15
    v_mul_f32 v8, v72, v184
    v_mul_f32 v12, v56, v184
    v_mul_f32 v9, v73, v185
    v_mul_f32 v13, v57, v185
    v_mul_f32 v10, v74, v186
    v_mul_f32 v14, v58, v186
    v_mul_f32 v11, v75, v187
    v_mul_f32 v15, v59, v187
    v_fma_f32 v56, v56, v168, -v8
    v_fma_f32 v72, v72, v168, v12
    v_fma_f32 v57, v57, v169, -v9
    v_fma_f32 v73, v73, v169, v13
    v_fma_f32 v58, v58, v170, -v10
    v_fma_f32 v74, v74, v170, v14
    v_fma_f32 v59, v59, v171, -v11
    v_fma_f32 v75, v75, v171, v15
    v_mul_f32 v8, v76, v188
    v_mul_f32 v12, v60, v188
    v_mul_f32 v9, v77, v189
    v_mul_f32 v13, v61, v189
    v_mul_f32 v10, v78, v190
    v_mul_f32 v14, v62, v190
    v_mul_f32 v11, v79, v191
    v_mul_f32 v15, v63, v191
    v_fma_f32 v60, v60, v172, -v8
    v_fma_f32 v76, v76, v172, v12
    v_fma_f32 v61, v61, v173, -v9
    v_fma_f32 v77, v77, v173, v13
    v_fma_f32 v62, v62, v174, -v10
    v_fma_f32 v78, v78, v174, v14
    v_fma_f32 v63, v63, v175, -v11
    v_fma_f32 v79, v79, v175, v15
    v_cvt_pk_bf16_f32 v112, v48, v49
    v_cvt_pk_bf16_f32 v128, v64, v65
    v_cvt_pk_bf16_f32 v113, v50, v51
    v_cvt_pk_bf16_f32 v129, v66, v67
    v_cvt_pk_bf16_f32 v114, v52, v53
    v_cvt_pk_bf16_f32 v130, v68, v69
    v_cvt_pk_bf16_f32 v115, v54, v55
    v_cvt_pk_bf16_f32 v131, v70, v71
    v_cvt_pk_bf16_f32 v116, v56, v57
    v_cvt_pk_bf16_f32 v132, v72, v73
    v_cvt_pk_bf16_f32 v117, v58, v59
    v_cvt_pk_bf16_f32 v133, v74, v75
    v_cvt_pk_bf16_f32 v118, v60, v61
    v_cvt_pk_bf16_f32 v134, v76, v77
    v_cvt_pk_bf16_f32 v119, v62, v63
    v_cvt_pk_bf16_f32 v135, v78, v79
    v_mul_f32 v8, v96, v240
    v_mul_f32 v12, v80, v240
    v_mul_f32 v9, v97, v241
    v_mul_f32 v13, v81, v241
    v_mul_f32 v10, v98, v242
    v_mul_f32 v14, v82, v242
    v_mul_f32 v11, v99, v243
    v_mul_f32 v15, v83, v243
    v_fma_f32 v80, v80, v224, -v8
    v_fma_f32 v96, v96, v224, v12
    v_fma_f32 v81, v81, v225, -v9
    v_fma_f32 v97, v97, v225, v13
    v_fma_f32 v82, v82, v226, -v10
    v_fma_f32 v98, v98, v226, v14
    v_fma_f32 v83, v83, v227, -v11
    v_fma_f32 v99, v99, v227, v15
    v_mul_f32 v8, v100, v244
    v_mul_f32 v12, v84, v244
    v_mul_f32 v9, v101, v245
    v_mul_f32 v13, v85, v245
    v_mul_f32 v10, v102, v246
    v_mul_f32 v14, v86, v246
    v_mul_f32 v11, v103, v247
    v_mul_f32 v15, v87, v247
    v_fma_f32 v84, v84, v228, -v8
    v_fma_f32 v100, v100, v228, v12
    v_fma_f32 v85, v85, v229, -v9
    v_fma_f32 v101, v101, v229, v13
    v_fma_f32 v86, v86, v230, -v10
    v_fma_f32 v102, v102, v230, v14
    v_fma_f32 v87, v87, v231, -v11
    v_fma_f32 v103, v103, v231, v15
    v_mul_f32 v8, v104, v248
    v_mul_f32 v12, v88, v248
    v_mul_f32 v9, v105, v249
    v_mul_f32 v13, v89, v249
    v_mul_f32 v10, v106, v250
    v_mul_f32 v14, v90, v250
    v_mul_f32 v11, v107, v251
    v_mul_f32 v15, v91, v251
    v_fma_f32 v88, v88, v232, -v8
    v_fma_f32 v104, v104, v232, v12
    v_fma_f32 v89, v89, v233, -v9
    v_fma_f32 v105, v105, v233, v13
    v_fma_f32 v90, v90, v234, -v10
    v_fma_f32 v106, v106, v234, v14
    v_fma_f32 v91, v91, v235, -v11
    v_fma_f32 v107, v107, v235, v15
    v_mul_f32 v8, v108, v252
    v_mul_f32 v12, v92, v252
    v_mul_f32 v9, v109, v253
    v_mul_f32 v13, v93, v253
    v_mul_f32 v10, v110, v254
    v_mul_f32 v14, v94, v254
    v_mul_f32 v11, v111, v255
    v_mul_f32 v15, v95, v255
    v_fma_f32 v92, v92, v236, -v8
    v_fma_f32 v108, v108, v236, v12
    v_fma_f32 v93, v93, v237, -v9
    v_fma_f32 v109, v109, v237, v13
    v_fma_f32 v94, v94, v238, -v10
    v_fma_f32 v110, v110, v238, v14
    v_fma_f32 v95, v95, v239, -v11
    v_fma_f32 v111, v111, v239, v15
    v_cvt_pk_bf16_f32 v120, v80, v81
    v_cvt_pk_bf16_f32 v136, v96, v97
    v_cvt_pk_bf16_f32 v121, v82, v83
    v_cvt_pk_bf16_f32 v137, v98, v99
    v_cvt_pk_bf16_f32 v122, v84, v85
    v_cvt_pk_bf16_f32 v138, v100, v101
    v_cvt_pk_bf16_f32 v123, v86, v87
    v_cvt_pk_bf16_f32 v139, v102, v103
    v_cvt_pk_bf16_f32 v124, v88, v89
    v_cvt_pk_bf16_f32 v140, v104, v105
    v_cvt_pk_bf16_f32 v125, v90, v91
    v_cvt_pk_bf16_f32 v141, v106, v107
    v_cvt_pk_bf16_f32 v126, v92, v93
    v_cvt_pk_bf16_f32 v142, v108, v109
    v_cvt_pk_bf16_f32 v127, v94, v95
    v_cvt_pk_bf16_f32 v143, v110, v111
    s_nop 1
    v_mfma_f32_32x32x16_bf16 v[48:63], a[32:35], v[112:115], 0
    v_mfma_f32_32x32x16_bf16 v[48:63], a[36:39], v[116:119], v[48:63]
    v_mfma_f32_32x32x16_bf16 v[48:63], a[48:51], v[128:131], v[48:63]
    v_mfma_f32_32x32x16_bf16 v[48:63], a[52:55], v[132:135], v[48:63]
    v_mfma_f32_32x32x16_bf16 v[64:79], a[32:35], v[128:131], 0
    v_mfma_f32_32x32x16_bf16 v[64:79], a[36:39], v[132:135], v[64:79]
    v_mfma_f32_32x32x16_bf16 v[64:79], a[40:43], v[112:115], v[64:79]
    v_mfma_f32_32x32x16_bf16 v[64:79], a[44:47], v[116:119], v[64:79]
    v_mfma_f32_32x32x16_bf16 v[80:95], a[32:35], v[120:123], 0
    v_mfma_f32_32x32x16_bf16 v[80:95], a[36:39], v[124:127], v[80:95]
    v_mfma_f32_32x32x16_bf16 v[80:95], a[48:51], v[136:139], v[80:95]
    v_mfma_f32_32x32x16_bf16 v[80:95], a[52:55], v[140:143], v[80:95]
    v_mfma_f32_32x32x16_bf16 v[96:111], a[32:35], v[136:139], 0
    v_mfma_f32_32x32x16_bf16 v[96:111], a[36:39], v[140:143], v[96:111]
    v_mfma_f32_32x32x16_bf16 v[96:111], a[40:43], v[120:123], v[96:111]
    v_mfma_f32_32x32x16_bf16 v[96:111], a[44:47], v[124:127], v[96:111]
    v_mul_u32_u24 v5, 4160, v4
    v_lshl_add_u32 v5, v3, 4, v5
    s_lshl_b32 s14, s3, 2
    v_add_u32 v5, s14, v5
    v_and_b32 v6, 31, v0
    v_mul_u32_u24 v6, 1040, v6
    v_lshrrev_b32 v7, 5, v0
    v_lshl_add_u32 v6, v7, 4, v6
    v_lshrrev_b32 v7, 4, v0
    v_mul_u32_u24 v7, 76800, v7
    v_and_b32 v8, 15, v0
    v_lshl_add_u32 v7, v8, 4, v7
    s_lshl_b32 s14, s12, 8
    s_add_u32 s14, s14, 56320
    s_cmp_eq_u32 s12, 80
    s_cselect_b32 s14, 55296, s14
    v_cvt_pk_bf16_f32 v112, v48, v64
    v_cvt_pk_bf16_f32 v113, v49, v65
    v_cvt_pk_bf16_f32 v114, v50, v66
    v_cvt_pk_bf16_f32 v115, v51, v67
    v_cvt_pk_bf16_f32 v116, v52, v68
    v_cvt_pk_bf16_f32 v117, v53, v69
    v_cvt_pk_bf16_f32 v118, v54, v70
    v_cvt_pk_bf16_f32 v119, v55, v71
    v_cvt_pk_bf16_f32 v120, v56, v72
    v_cvt_pk_bf16_f32 v121, v57, v73
    v_cvt_pk_bf16_f32 v122, v58, v74
    v_cvt_pk_bf16_f32 v123, v59, v75
    v_cvt_pk_bf16_f32 v124, v60, v76
    v_cvt_pk_bf16_f32 v125, v61, v77
    v_cvt_pk_bf16_f32 v126, v62, v78
    v_cvt_pk_bf16_f32 v127, v63, v79
    ds_write_b32 v5, v112 offset:0
    ds_write_b32 v5, v113 offset:1040
    ds_write_b32 v5, v114 offset:2080
    ds_write_b32 v5, v115 offset:3120
    ds_write_b32 v5, v116 offset:8320
    ds_write_b32 v5, v117 offset:9360
    ds_write_b32 v5, v118 offset:10400
    ds_write_b32 v5, v119 offset:11440
    ds_write_b32 v5, v120 offset:16640
    ds_write_b32 v5, v121 offset:17680
    ds_write_b32 v5, v122 offset:18720
    ds_write_b32 v5, v123 offset:19760
    ds_write_b32 v5, v124 offset:24960
    ds_write_b32 v5, v125 offset:26000
    ds_write_b32 v5, v126 offset:27040
    ds_write_b32 v5, v127 offset:28080
    s_nop 7
    v_cvt_pk_bf16_f32 v128, v80, v96
    v_cvt_pk_bf16_f32 v129, v81, v97
    v_cvt_pk_bf16_f32 v130, v82, v98
    v_cvt_pk_bf16_f32 v131, v83, v99
    v_cvt_pk_bf16_f32 v132, v84, v100
    v_cvt_pk_bf16_f32 v133, v85, v101
    v_cvt_pk_bf16_f32 v134, v86, v102
    v_cvt_pk_bf16_f32 v135, v87, v103
    v_cvt_pk_bf16_f32 v136, v88, v104
    v_cvt_pk_bf16_f32 v137, v89, v105
    v_cvt_pk_bf16_f32 v138, v90, v106
    v_cvt_pk_bf16_f32 v139, v91, v107
    v_cvt_pk_bf16_f32 v140, v92, v108
    v_cvt_pk_bf16_f32 v141, v93, v109
    v_cvt_pk_bf16_f32 v142, v94, v110
    v_cvt_pk_bf16_f32 v143, v95, v111
    ds_write_b32 v5, v128 offset:512
    ds_write_b32 v5, v129 offset:1552
    ds_write_b32 v5, v130 offset:2592
    ds_write_b32 v5, v131 offset:3632
    ds_write_b32 v5, v132 offset:8832
    ds_write_b32 v5, v133 offset:9872
    ds_write_b32 v5, v134 offset:10912
    ds_write_b32 v5, v135 offset:11952
    ds_write_b32 v5, v136 offset:17152
    ds_write_b32 v5, v137 offset:18192
    ds_write_b32 v5, v138 offset:19232
    ds_write_b32 v5, v139 offset:20272
    ds_write_b32 v5, v140 offset:25472
    ds_write_b32 v5, v141 offset:26512
    ds_write_b32 v5, v142 offset:27552
    ds_write_b32 v5, v143 offset:28592
    s_waitcnt lgkmcnt(0)
    s_barrier
    ds_read_b128 v[16:19], v6 offset:0
    ds_read_b128 v[20:23], v6 offset:128
    ds_read_b128 v[24:27], v6 offset:256
    ds_read_b128 v[28:31], v6 offset:384
    ds_read_b128 v[32:35], v6 offset:512
    ds_read_b128 v[36:39], v6 offset:640
    ds_read_b128 v[40:43], v6 offset:768
    ds_read_b128 v[44:47], v6 offset:896
    s_mov_b32 s15, s14
    s_waitcnt lgkmcnt(7)
    buffer_store_dwordx4 v[16:19], v7, s[28:31], s15 offen sc0 sc1
    s_add_u32 s15, s15, 1228800
    s_waitcnt lgkmcnt(6)
    buffer_store_dwordx4 v[20:23], v7, s[28:31], s15 offen sc0 sc1
    s_add_u32 s15, s15, 1228800
    s_waitcnt lgkmcnt(5)
    buffer_store_dwordx4 v[24:27], v7, s[28:31], s15 offen sc0 sc1
    s_add_u32 s15, s15, 1228800
    s_waitcnt lgkmcnt(4)
    buffer_store_dwordx4 v[28:31], v7, s[28:31], s15 offen sc0 sc1
    s_add_u32 s15, s15, 1228800
    s_waitcnt lgkmcnt(3)
    buffer_store_dwordx4 v[32:35], v7, s[28:31], s15 offen sc0 sc1
    s_add_u32 s15, s15, 1228800
    s_waitcnt lgkmcnt(2)
    buffer_store_dwordx4 v[36:39], v7, s[28:31], s15 offen sc0 sc1
    s_add_u32 s15, s15, 1228800
    s_waitcnt lgkmcnt(1)
    buffer_store_dwordx4 v[40:43], v7, s[28:31], s15 offen sc0 sc1
    s_add_u32 s15, s15, 1228800
    s_waitcnt lgkmcnt(0)
    buffer_store_dwordx4 v[44:47], v7, s[28:31], s15 offen sc0 sc1
    s_add_u32 s15, s15, 1228800
    s_cmp_lg_u32 s12, 80
    s_cbranch_scc1 K2_FEND
    v_mov_b32 v60, 0
    v_mov_b32 v61, 0
    v_mov_b32 v62, 0
    v_mov_b32 v63, 0
    buffer_store_dwordx4 v[60:63], v7, s[28:31], s14 offen offset:256 sc0 sc1
    buffer_store_dwordx4 v[60:63], v7, s[28:31], s14 offen offset:512 sc0 sc1
    buffer_store_dwordx4 v[60:63], v7, s[28:31], s14 offen offset:768 sc0 sc1
    s_add_u32 s14, s14, 1228800
    buffer_store_dwordx4 v[60:63], v7, s[28:31], s14 offen offset:256 sc0 sc1
    buffer_store_dwordx4 v[60:63], v7, s[28:31], s14 offen offset:512 sc0 sc1
    buffer_store_dwordx4 v[60:63], v7, s[28:31], s14 offen offset:768 sc0 sc1
    s_add_u32 s14, s14, 1228800
    buffer_store_dwordx4 v[60:63], v7, s[28:31], s14 offen offset:256 sc0 sc1
    buffer_store_dwordx4 v[60:63], v7, s[28:31], s14 offen offset:512 sc0 sc1
    buffer_store_dwordx4 v[60:63], v7, s[28:31], s14 offen offset:768 sc0 sc1
    s_add_u32 s14, s14, 1228800
    buffer_store_dwordx4 v[60:63], v7, s[28:31], s14 offen offset:256 sc0 sc1
    buffer_store_dwordx4 v[60:63], v7, s[28:31], s14 offen offset:512 sc0 sc1
    buffer_store_dwordx4 v[60:63], v7, s[28:31], s14 offen offset:768 sc0 sc1
    s_add_u32 s14, s14, 1228800
    buffer_store_dwordx4 v[60:63], v7, s[28:31], s14 offen offset:256 sc0 sc1
    buffer_store_dwordx4 v[60:63], v7, s[28:31], s14 offen offset:512 sc0 sc1
    buffer_store_dwordx4 v[60:63], v7, s[28:31], s14 offen offset:768 sc0 sc1
    s_add_u32 s14, s14, 1228800
    buffer_store_dwordx4 v[60:63], v7, s[28:31], s14 offen offset:256 sc0 sc1
    buffer_store_dwordx4 v[60:63], v7, s[28:31], s14 offen offset:512 sc0 sc1
    buffer_store_dwordx4 v[60:63], v7, s[28:31], s14 offen offset:768 sc0 sc1
    s_add_u32 s14, s14, 1228800
    buffer_store_dwordx4 v[60:63], v7, s[28:31], s14 offen offset:256 sc0 sc1
    buffer_store_dwordx4 v[60:63], v7, s[28:31], s14 offen offset:512 sc0 sc1
    buffer_store_dwordx4 v[60:63], v7, s[28:31], s14 offen offset:768 sc0 sc1
    s_add_u32 s14, s14, 1228800
    buffer_store_dwordx4 v[60:63], v7, s[28:31], s14 offen offset:256 sc0 sc1
    buffer_store_dwordx4 v[60:63], v7, s[28:31], s14 offen offset:512 sc0 sc1
    buffer_store_dwordx4 v[60:63], v7, s[28:31], s14 offen offset:768 sc0 sc1
    s_add_u32 s14, s14, 1228800
K2_FEND:
    s_endpgm
K2_SIDE:
    s_getpc_b64 s[46:47]
CPF5:
    s_add_u32 s46, s46, K2_SIDE-CPF5
    s_addc_u32 s47, s47, (K2_SIDE-CPF5)>>32
    v_lshlrev_b32 v250, 6, v0
    v_add_u32 v250, 0, v250
    v_min_u32 v250, K2_END-K2_SIDE-4, v250
    v_mov_b32 v251, s47
    v_add_co_u32 v250, vcc, s46, v250
    v_addc_co_u32 v251, vcc, 0, v251, vcc
    global_load_dword v252, v[250:251], off
    s_sub_u32 s12, s2, 225
    s_mul_i32 s13, s12, 81920
    s_mul_i32 s14, s3, 20480
    s_add_u32 s13, s13, s14
    v_lshlrev_b32 v3, 4, v2
    s_waitcnt lgkmcnt(0)
    s_mov_b32 s16, s8
    s_mov_b32 s17, s9
    s_mov_b32 s18, 0x21c000
    s_mov_b32 s19, 0x00020000
    s_add_u32 s20, s10, 0x1300000
    s_addc_u32 s21, s11, 0
    s_mov_b32 s22, 0x2ee000
    s_mov_b32 s23, 0x00020000
    s_mov_b32 s40, s4
    s_mov_b32 s41, s5
    s_mov_b32 s42, 0x21c000
    s_mov_b32 s43, 0x00020000
    s_add_u32 s48, s10, 0x600000
    s_addc_u32 s49, s11, 0
    s_mov_b32 s50, 0x280000
    s_mov_b32 s51, 0x00020000
    s_sub_u32 s34, s2, 224
    s_lshr_b32 s34, s34, 3
    s_lshl_b32 s34, s34, 2
    s_add_u32 s34, s34, s3
    s_and_b32 s35, s2, 1
    s_mul_i32 s35, s35, 1536
    s_add_u32 s35, s35, 442368
    s_and_b32 s36, s2, 6
    s_lshl_b32 s36, s36, 3
    s_add_u32 s36, s36, s34
    s_mul_i32 s36, s36, 40960
    v_mul_u32_u24 v13, 3456, v2
    v_lshlrev_b32 v14, 7, v2
    s_mul_i32 s38, s34, 4370
    s_lshr_b32 s38, s38, 16
    s_mul_i32 s39, s38, 15
    s_sub_u32 s37, s34, s39
    s_lshl_b32 s37, s37, 7
    s_mul_i32 s38, s38, 221184
    s_add_u32 s37, s37, s38
    s_add_u32 s37, s37, s35
    buffer_load_dword a0, v13, s[40:43], s37 offen
    s_add_u32 s34, s34, 16
    s_add_u32 s36, s36, 8192
    buffer_load_dword a16, v14, s[48:51], s36 offen
    s_mul_i32 s38, s34, 4370
    s_lshr_b32 s38, s38, 16
    s_mul_i32 s39, s38, 15
    s_sub_u32 s37, s34, s39
    s_lshl_b32 s37, s37, 7
    s_mul_i32 s38, s38, 221184
    s_add_u32 s37, s37, s38
    s_add_u32 s37, s37, s35
    buffer_load_dword a1, v13, s[40:43], s37 offen
    s_add_u32 s34, s34, 16
    s_mul_i32 s38, s34, 4370
    s_lshr_b32 s38, s38, 16
    s_mul_i32 s39, s38, 15
    s_sub_u32 s37, s34, s39
    s_lshl_b32 s37, s37, 7
    s_mul_i32 s38, s38, 221184
    s_add_u32 s37, s37, s38
    s_add_u32 s37, s37, s35
    buffer_load_dword a2, v13, s[40:43], s37 offen
    s_add_u32 s34, s34, 16
    s_add_u32 s36, s36, 8192
    buffer_load_dword a18, v14, s[48:51], s36 offen
    s_lshl_b32 s24, s12, 2
    s_add_u32 s24, s24, s3
    s_cmp_ge_u32 s24, 41
    s_cbranch_scc1 K2_S_NOTG
    s_sub_u32 s25, s24, 4
    s_lshr_b32 s25, s25, 1
    s_and_b32 s26, s24, 1
    s_and_b32 s34, s25, 3
    s_add_u32 s34, s34, 1
    s_lshr_b32 s35, s25, 2
    s_add_u32 s25, s25, 59
    s_add_u32 s36, s24, 55
    s_cmp_lt_u32 s24, 4
    s_cselect_b32 s26, 0, s26
    s_cselect_b32 s34, 0, s34
    s_cselect_b32 s35, s24, s35
    s_cselect_b32 s25, s36, s25
    s_mul_i32 s35, s35, 80
    s_add_u32 s34, s34, s35
    s_cmp_eq_u32 s26, 1
    s_cselect_b32 s35, 0x3f400000, 0
    s_sub_u32 s36, s24, 36
    s_cmp_ge_u32 s24, 36
    s_cselect_b32 s26, s36, s26
    s_cselect_b32 s34, 320, s34
    s_cselect_b32 s35, 0, s35
    s_cselect_b32 s25, 54, s25
    v_and_b32 v4, 15, v2
    v_lshrrev_b32 v5, 4, v2
    v_cvt_f32_u32 v4, v4
    v_mul_u32_u24 v5, 20, v5
    v_add_u32 v5, s34, v5
    v_mov_b32 v7, 0x35cccccd
    v_mov_b32 v8, 0x354ccccd
    v_mov_b32 v9, 0xb5cccccd
    s_mul_i32 s27, s26, 76800
    s_lshl_b32 s25, s25, 10
    s_add_u32 s27, s27, s25
    v_mov_b32 v10, 320
    v_add_u32 v6, 0, v5
    v_cvt_f32_u32 v16, v6
    v_cmp_eq_u32 vcc, 0, v6
    v_cmp_le_u32 s[28:29], v10, v6
    v_cmp_lt_u32 s[30:31], v10, v6
    s_or_b64 s[28:29], s[28:29], vcc
    s_nop 1
    v_cndmask_b32 v20, v7, v8, s[28:29]
    v_cndmask_b32 v24, v9, 0, s[28:29]
    v_cndmask_b32 v20, v20, 0, s[30:31]
    v_mov_b32 v10, 320
    v_add_u32 v6, 5, v5
    v_cvt_f32_u32 v17, v6
    v_cmp_eq_u32 vcc, 0, v6
    v_cmp_le_u32 s[28:29], v10, v6
    v_cmp_lt_u32 s[30:31], v10, v6
    s_or_b64 s[28:29], s[28:29], vcc
    s_nop 1
    v_cndmask_b32 v21, v7, v8, s[28:29]
    v_cndmask_b32 v25, v9, 0, s[28:29]
    v_cndmask_b32 v21, v21, 0, s[30:31]
    v_mov_b32 v10, 320
    v_add_u32 v6, 10, v5
    v_cvt_f32_u32 v18, v6
    v_cmp_eq_u32 vcc, 0, v6
    v_cmp_le_u32 s[28:29], v10, v6
    v_cmp_lt_u32 s[30:31], v10, v6
    s_or_b64 s[28:29], s[28:29], vcc
    s_nop 1
    v_cndmask_b32 v22, v7, v8, s[28:29]
    v_cndmask_b32 v26, v9, 0, s[28:29]
    v_cndmask_b32 v22, v22, 0, s[30:31]
    v_mov_b32 v10, 320
    v_add_u32 v6, 15, v5
    v_cvt_f32_u32 v19, v6
    v_cmp_eq_u32 vcc, 0, v6
    v_cmp_le_u32 s[28:29], v10, v6
    v_cmp_lt_u32 s[30:31], v10, v6
    s_or_b64 s[28:29], s[28:29], vcc
    s_nop 1
    v_cndmask_b32 v23, v7, v8, s[28:29]
    v_cndmask_b32 v27, v9, 0, s[28:29]
    v_cndmask_b32 v23, v23, 0, s[30:31]
    v_add_f32 v11, 0x00000000, v4
    v_mul_f32 v28, v11, v16
    v_mul_f32 v29, v11, v17
    v_mul_f32 v30, v11, v18
    v_mul_f32 v31, v11, v19
    v_mul_f32 v28, 0x3acccccd, v28
    v_mul_f32 v29, 0x3acccccd, v29
    v_mul_f32 v30, 0x3acccccd, v30
    v_mul_f32 v31, 0x3acccccd, v31
    v_fract_f32 v28, v28
    v_add_f32 v28, s35, v28
    v_fract_f32 v29, v29
    v_add_f32 v29, s35, v29
    v_fract_f32 v30, v30
    v_add_f32 v30, s35, v30
    v_fract_f32 v31, v31
    v_add_f32 v31, s35, v31
    v_cos_f32 v32, v28
    v_sin_f32 v36, v28
    v_cos_f32 v33, v29
    v_sin_f32 v37, v29
    v_cos_f32 v34, v30
    v_sin_f32 v38, v30
    v_cos_f32 v35, v31
    v_sin_f32 v39, v31
    v_mul_f32 v32, v32, v20
    v_mul_f32 v36, v36, v24
    v_mul_f32 v33, v33, v21
    v_mul_f32 v37, v37, v25
    v_mul_f32 v34, v34, v22
    v_mul_f32 v38, v38, v26
    v_mul_f32 v35, v35, v23
    v_mul_f32 v39, v39, v27
    v_cvt_pk_bf16_f32 v40, v32, v36
    v_cvt_pk_bf16_f32 v41, v33, v37
    v_cvt_pk_bf16_f32 v42, v34, v38
    v_cvt_pk_bf16_f32 v43, v35, v39
    buffer_store_dwordx4 v[40:43], v3, s[20:23], s27 offen sc0 sc1
    s_add_u32 s27, s27, 384000
    v_add_f32 v11, 0x41800000, v4
    v_mul_f32 v28, v11, v16
    v_mul_f32 v29, v11, v17
    v_mul_f32 v30, v11, v18
    v_mul_f32 v31, v11, v19
    v_mul_f32 v28, 0x3acccccd, v28
    v_mul_f32 v29, 0x3acccccd, v29
    v_mul_f32 v30, 0x3acccccd, v30
    v_mul_f32 v31, 0x3acccccd, v31
    v_fract_f32 v28, v28
    v_add_f32 v28, s35, v28
    v_fract_f32 v29, v29
    v_add_f32 v29, s35, v29
    v_fract_f32 v30, v30
    v_add_f32 v30, s35, v30
    v_fract_f32 v31, v31
    v_add_f32 v31, s35, v31
    v_cos_f32 v32, v28
    v_sin_f32 v36, v28
    v_cos_f32 v33, v29
    v_sin_f32 v37, v29
    v_cos_f32 v34, v30
    v_sin_f32 v38, v30
    v_cos_f32 v35, v31
    v_sin_f32 v39, v31
    v_mul_f32 v32, v32, v20
    v_mul_f32 v36, v36, v24
    v_mul_f32 v33, v33, v21
    v_mul_f32 v37, v37, v25
    v_mul_f32 v34, v34, v22
    v_mul_f32 v38, v38, v26
    v_mul_f32 v35, v35, v23
    v_mul_f32 v39, v39, v27
    v_cvt_pk_bf16_f32 v44, v32, v36
    v_cvt_pk_bf16_f32 v45, v33, v37
    v_cvt_pk_bf16_f32 v46, v34, v38
    v_cvt_pk_bf16_f32 v47, v35, v39
    buffer_store_dwordx4 v[44:47], v3, s[20:23], s27 offen sc0 sc1
    s_add_u32 s27, s27, 384000
    v_add_f32 v11, 0x42000000, v4
    v_mul_f32 v28, v11, v16
    v_mul_f32 v29, v11, v17
    v_mul_f32 v30, v11, v18
    v_mul_f32 v31, v11, v19
    v_mul_f32 v28, 0x3acccccd, v28
    v_mul_f32 v29, 0x3acccccd, v29
    v_mul_f32 v30, 0x3acccccd, v30
    v_mul_f32 v31, 0x3acccccd, v31
    v_fract_f32 v28, v28
    v_add_f32 v28, s35, v28
    v_fract_f32 v29, v29
    v_add_f32 v29, s35, v29
    v_fract_f32 v30, v30
    v_add_f32 v30, s35, v30
    v_fract_f32 v31, v31
    v_add_f32 v31, s35, v31
    v_cos_f32 v32, v28
    v_sin_f32 v36, v28
    v_cos_f32 v33, v29
    v_sin_f32 v37, v29
    v_cos_f32 v34, v30
    v_sin_f32 v38, v30
    v_cos_f32 v35, v31
    v_sin_f32 v39, v31
    v_mul_f32 v32, v32, v20
    v_mul_f32 v36, v36, v24
    v_mul_f32 v33, v33, v21
    v_mul_f32 v37, v37, v25
    v_mul_f32 v34, v34, v22
    v_mul_f32 v38, v38, v26
    v_mul_f32 v35, v35, v23
    v_mul_f32 v39, v39, v27
    v_cvt_pk_bf16_f32 v48, v32, v36
    v_cvt_pk_bf16_f32 v49, v33, v37
    v_cvt_pk_bf16_f32 v50, v34, v38
    v_cvt_pk_bf16_f32 v51, v35, v39
    buffer_store_dwordx4 v[48:51], v3, s[20:23], s27 offen sc0 sc1
    s_add_u32 s27, s27, 384000
    v_add_f32 v11, 0x42400000, v4
    v_mul_f32 v28, v11, v16
    v_mul_f32 v29, v11, v17
    v_mul_f32 v30, v11, v18
    v_mul_f32 v31, v11, v19
    v_mul_f32 v28, 0x3acccccd, v28
    v_mul_f32 v29, 0x3acccccd, v29
    v_mul_f32 v30, 0x3acccccd, v30
    v_mul_f32 v31, 0x3acccccd, v31
    v_fract_f32 v28, v28
    v_add_f32 v28, s35, v28
    v_fract_f32 v29, v29
    v_add_f32 v29, s35, v29
    v_fract_f32 v30, v30
    v_add_f32 v30, s35, v30
    v_fract_f32 v31, v31
    v_add_f32 v31, s35, v31
    v_cos_f32 v32, v28
    v_sin_f32 v36, v28
    v_cos_f32 v33, v29
    v_sin_f32 v37, v29
    v_cos_f32 v34, v30
    v_sin_f32 v38, v30
    v_cos_f32 v35, v31
    v_sin_f32 v39, v31
    v_mul_f32 v32, v32, v20
    v_mul_f32 v36, v36, v24
    v_mul_f32 v33, v33, v21
    v_mul_f32 v37, v37, v25
    v_mul_f32 v34, v34, v22
    v_mul_f32 v38, v38, v26
    v_mul_f32 v35, v35, v23
    v_mul_f32 v39, v39, v27
    v_cvt_pk_bf16_f32 v52, v32, v36
    v_cvt_pk_bf16_f32 v53, v33, v37
    v_cvt_pk_bf16_f32 v54, v34, v38
    v_cvt_pk_bf16_f32 v55, v35, v39
    buffer_store_dwordx4 v[52:55], v3, s[20:23], s27 offen sc0 sc1
    s_add_u32 s27, s27, 384000
    v_add_f32 v11, 0x42800000, v4
    v_mul_f32 v28, v11, v16
    v_mul_f32 v29, v11, v17
    v_mul_f32 v30, v11, v18
    v_mul_f32 v31, v11, v19
    v_mul_f32 v28, 0x3acccccd, v28
    v_mul_f32 v29, 0x3acccccd, v29
    v_mul_f32 v30, 0x3acccccd, v30
    v_mul_f32 v31, 0x3acccccd, v31
    v_fract_f32 v28, v28
    v_add_f32 v28, s35, v28
    v_fract_f32 v29, v29
    v_add_f32 v29, s35, v29
    v_fract_f32 v30, v30
    v_add_f32 v30, s35, v30
    v_fract_f32 v31, v31
    v_add_f32 v31, s35, v31
    v_cos_f32 v32, v28
    v_sin_f32 v36, v28
    v_cos_f32 v33, v29
    v_sin_f32 v37, v29
    v_cos_f32 v34, v30
    v_sin_f32 v38, v30
    v_cos_f32 v35, v31
    v_sin_f32 v39, v31
    v_mul_f32 v32, v32, v20
    v_mul_f32 v36, v36, v24
    v_mul_f32 v33, v33, v21
    v_mul_f32 v37, v37, v25
    v_mul_f32 v34, v34, v22
    v_mul_f32 v38, v38, v26
    v_mul_f32 v35, v35, v23
    v_mul_f32 v39, v39, v27
    v_cvt_pk_bf16_f32 v56, v32, v36
    v_cvt_pk_bf16_f32 v57, v33, v37
    v_cvt_pk_bf16_f32 v58, v34, v38
    v_cvt_pk_bf16_f32 v59, v35, v39
    buffer_store_dwordx4 v[56:59], v3, s[20:23], s27 offen sc0 sc1
    s_add_u32 s27, s27, 384000
    v_add_f32 v11, 0x42a00000, v4
    v_mul_f32 v28, v11, v16
    v_mul_f32 v29, v11, v17
    v_mul_f32 v30, v11, v18
    v_mul_f32 v31, v11, v19
    v_mul_f32 v28, 0x3acccccd, v28
    v_mul_f32 v29, 0x3acccccd, v29
    v_mul_f32 v30, 0x3acccccd, v30
    v_mul_f32 v31, 0x3acccccd, v31
    v_fract_f32 v28, v28
    v_add_f32 v28, s35, v28
    v_fract_f32 v29, v29
    v_add_f32 v29, s35, v29
    v_fract_f32 v30, v30
    v_add_f32 v30, s35, v30
    v_fract_f32 v31, v31
    v_add_f32 v31, s35, v31
    v_cos_f32 v32, v28
    v_sin_f32 v36, v28
    v_cos_f32 v33, v29
    v_sin_f32 v37, v29
    v_cos_f32 v34, v30
    v_sin_f32 v38, v30
    v_cos_f32 v35, v31
    v_sin_f32 v39, v31
    v_mul_f32 v32, v32, v20
    v_mul_f32 v36, v36, v24
    v_mul_f32 v33, v33, v21
    v_mul_f32 v37, v37, v25
    v_mul_f32 v34, v34, v22
    v_mul_f32 v38, v38, v26
    v_mul_f32 v35, v35, v23
    v_mul_f32 v39, v39, v27
    v_cvt_pk_bf16_f32 v60, v32, v36
    v_cvt_pk_bf16_f32 v61, v33, v37
    v_cvt_pk_bf16_f32 v62, v34, v38
    v_cvt_pk_bf16_f32 v63, v35, v39
    buffer_store_dwordx4 v[60:63], v3, s[20:23], s27 offen sc0 sc1
    s_add_u32 s27, s27, 384000
    v_add_f32 v11, 0x42c00000, v4
    v_mul_f32 v28, v11, v16
    v_mul_f32 v29, v11, v17
    v_mul_f32 v30, v11, v18
    v_mul_f32 v31, v11, v19
    v_mul_f32 v28, 0x3acccccd, v28
    v_mul_f32 v29, 0x3acccccd, v29
    v_mul_f32 v30, 0x3acccccd, v30
    v_mul_f32 v31, 0x3acccccd, v31
    v_fract_f32 v28, v28
    v_add_f32 v28, s35, v28
    v_fract_f32 v29, v29
    v_add_f32 v29, s35, v29
    v_fract_f32 v30, v30
    v_add_f32 v30, s35, v30
    v_fract_f32 v31, v31
    v_add_f32 v31, s35, v31
    v_cos_f32 v32, v28
    v_sin_f32 v36, v28
    v_cos_f32 v33, v29
    v_sin_f32 v37, v29
    v_cos_f32 v34, v30
    v_sin_f32 v38, v30
    v_cos_f32 v35, v31
    v_sin_f32 v39, v31
    v_mul_f32 v32, v32, v20
    v_mul_f32 v36, v36, v24
    v_mul_f32 v33, v33, v21
    v_mul_f32 v37, v37, v25
    v_mul_f32 v34, v34, v22
    v_mul_f32 v38, v38, v26
    v_mul_f32 v35, v35, v23
    v_mul_f32 v39, v39, v27
    v_cvt_pk_bf16_f32 v64, v32, v36
    v_cvt_pk_bf16_f32 v65, v33, v37
    v_cvt_pk_bf16_f32 v66, v34, v38
    v_cvt_pk_bf16_f32 v67, v35, v39
    buffer_store_dwordx4 v[64:67], v3, s[20:23], s27 offen sc0 sc1
    s_add_u32 s27, s27, 384000
    v_add_f32 v11, 0x42e00000, v4
    v_mul_f32 v28, v11, v16
    v_mul_f32 v29, v11, v17
    v_mul_f32 v30, v11, v18
    v_mul_f32 v31, v11, v19
    v_mul_f32 v28, 0x3acccccd, v28
    v_mul_f32 v29, 0x3acccccd, v29
    v_mul_f32 v30, 0x3acccccd, v30
    v_mul_f32 v31, 0x3acccccd, v31
    v_fract_f32 v28, v28
    v_add_f32 v28, s35, v28
    v_fract_f32 v29, v29
    v_add_f32 v29, s35, v29
    v_fract_f32 v30, v30
    v_add_f32 v30, s35, v30
    v_fract_f32 v31, v31
    v_add_f32 v31, s35, v31
    v_cos_f32 v32, v28
    v_sin_f32 v36, v28
    v_cos_f32 v33, v29
    v_sin_f32 v37, v29
    v_cos_f32 v34, v30
    v_sin_f32 v38, v30
    v_cos_f32 v35, v31
    v_sin_f32 v39, v31
    v_mul_f32 v32, v32, v20
    v_mul_f32 v36, v36, v24
    v_mul_f32 v33, v33, v21
    v_mul_f32 v37, v37, v25
    v_mul_f32 v34, v34, v22
    v_mul_f32 v38, v38, v26
    v_mul_f32 v35, v35, v23
    v_mul_f32 v39, v39, v27
    v_cvt_pk_bf16_f32 v68, v32, v36
    v_cvt_pk_bf16_f32 v69, v33, v37
    v_cvt_pk_bf16_f32 v70, v34, v38
    v_cvt_pk_bf16_f32 v71, v35, v39
    buffer_store_dwordx4 v[68:71], v3, s[20:23], s27 offen sc0 sc1
    s_add_u32 s27, s27, 384000
K2_S_NOTG:
    s_add_u32 m0, s14, 0
    s_add_u32 s15, s13, 0
    buffer_load_dwordx4 v3, s[16:19], s15 offen offset:0 lds
    buffer_load_dwordx4 v3, s[16:19], s15 offen offset:1024 lds
    buffer_load_dwordx4 v3, s[16:19], s15 offen offset:2048 lds
    buffer_load_dwordx4 v3, s[16:19], s15 offen offset:3072 lds
    s_add_u32 m0, s14, 4096
    s_add_u32 s15, s13, 4096
    buffer_load_dwordx4 v3, s[16:19], s15 offen offset:0 lds
    buffer_load_dwordx4 v3, s[16:19], s15 offen offset:1024 lds
    buffer_load_dwordx4 v3, s[16:19], s15 offen offset:2048 lds
    buffer_load_dwordx4 v3, s[16:19], s15 offen offset:3072 lds
    s_add_u32 m0, s14, 8192
    s_add_u32 s15, s13, 8192
    buffer_load_dwordx4 v3, s[16:19], s15 offen offset:0 lds
    buffer_load_dwordx4 v3, s[16:19], s15 offen offset:1024 lds
    buffer_load_dwordx4 v3, s[16:19], s15 offen offset:2048 lds
    buffer_load_dwordx4 v3, s[16:19], s15 offen offset:3072 lds
    s_add_u32 m0, s14, 12288
    s_add_u32 s15, s13, 12288
    buffer_load_dwordx4 v3, s[16:19], s15 offen offset:0 lds
    buffer_load_dwordx4 v3, s[16:19], s15 offen offset:1024 lds
    buffer_load_dwordx4 v3, s[16:19], s15 offen offset:2048 lds
    buffer_load_dwordx4 v3, s[16:19], s15 offen offset:3072 lds
    s_add_u32 m0, s14, 16384
    s_add_u32 s15, s13, 16384
    buffer_load_dwordx4 v3, s[16:19], s15 offen offset:0 lds
    buffer_load_dwordx4 v3, s[16:19], s15 offen offset:1024 lds
    buffer_load_dwordx4 v3, s[16:19], s15 offen offset:2048 lds
    buffer_load_dwordx4 v3, s[16:19], s15 offen offset:3072 lds
    v_bfe_u32 v4, v2, 4, 1
    v_lshrrev_b32 v5, 5, v2
    v_bfe_u32 v6, v2, 2, 2
    v_and_b32 v7, 3, v2
    v_lshl_add_u32 v6, v5, 2, v6
    v_lshl_add_u32 v6, v4, 4, v6
    v_mul_u32_u24 v6, 1280, v6
    v_mul_u32_u24 v7, 8, v7
    s_mul_i32 s14, s3, 64
    v_add3_u32 v6, v6, v7, s14
    v_add_u32 v7, 40960, v6
    s_mul_i32 s15, s3, 768000
    s_lshl_b32 s13, s12, 11
    s_add_u32 s15, s15, s13
    s_waitcnt vmcnt(0)
    s_barrier
    ds_read_b64_tr_b16 v[80:81], v6 offset:0
    ds_read_b64_tr_b16 v[82:83], v6 offset:10240
    ds_read_b64_tr_b16 v[84:85], v6 offset:256
    ds_read_b64_tr_b16 v[86:87], v6 offset:10496
    ds_read_b64_tr_b16 v[88:89], v6 offset:512
    ds_read_b64_tr_b16 v[90:91], v6 offset:10752
    ds_read_b64_tr_b16 v[92:93], v6 offset:768
    ds_read_b64_tr_b16 v[94:95], v6 offset:11008
    ds_read_b64_tr_b16 v[96:97], v6 offset:1024
    ds_read_b64_tr_b16 v[98:99], v6 offset:11264
    ds_read_b64_tr_b16 v[100:101], v6 offset:32
    ds_read_b64_tr_b16 v[102:103], v6 offset:10272
    ds_read_b64_tr_b16 v[104:105], v6 offset:288
    ds_read_b64_tr_b16 v[106:107], v6 offset:10528
    ds_read_b64_tr_b16 v[108:109], v6 offset:544
    ds_read_b64_tr_b16 v[110:111], v6 offset:10784
    ds_read_b64_tr_b16 v[112:113], v6 offset:800
    ds_read_b64_tr_b16 v[114:115], v6 offset:11040
    ds_read_b64_tr_b16 v[116:117], v6 offset:1056
    ds_read_b64_tr_b16 v[118:119], v6 offset:11296
    s_waitcnt lgkmcnt(0)
    s_add_u32 s13, s15, 0
    buffer_store_dwordx4 v[80:83], v3, s[20:23], s13 offen sc0 sc1
    s_add_u32 s13, s15, 76800
    buffer_store_dwordx4 v[84:87], v3, s[20:23], s13 offen sc0 sc1
    s_add_u32 s13, s15, 153600
    buffer_store_dwordx4 v[88:91], v3, s[20:23], s13 offen sc0 sc1
    s_add_u32 s13, s15, 230400
    buffer_store_dwordx4 v[92:95], v3, s[20:23], s13 offen sc0 sc1
    s_add_u32 s13, s15, 307200
    buffer_store_dwordx4 v[96:99], v3, s[20:23], s13 offen sc0 sc1
    s_add_u32 s13, s15, 384000
    buffer_store_dwordx4 v[100:103], v3, s[20:23], s13 offen sc0 sc1
    s_add_u32 s13, s15, 460800
    buffer_store_dwordx4 v[104:107], v3, s[20:23], s13 offen sc0 sc1
    s_add_u32 s13, s15, 537600
    buffer_store_dwordx4 v[108:111], v3, s[20:23], s13 offen sc0 sc1
    s_add_u32 s13, s15, 614400
    buffer_store_dwordx4 v[112:115], v3, s[20:23], s13 offen sc0 sc1
    s_add_u32 s13, s15, 691200
    buffer_store_dwordx4 v[116:119], v3, s[20:23], s13 offen sc0 sc1
    ds_read_b64_tr_b16 v[120:121], v7 offset:0
    ds_read_b64_tr_b16 v[122:123], v7 offset:10240
    ds_read_b64_tr_b16 v[124:125], v7 offset:256
    ds_read_b64_tr_b16 v[126:127], v7 offset:10496
    ds_read_b64_tr_b16 v[128:129], v7 offset:512
    ds_read_b64_tr_b16 v[130:131], v7 offset:10752
    ds_read_b64_tr_b16 v[132:133], v7 offset:768
    ds_read_b64_tr_b16 v[134:135], v7 offset:11008
    ds_read_b64_tr_b16 v[136:137], v7 offset:1024
    ds_read_b64_tr_b16 v[138:139], v7 offset:11264
    ds_read_b64_tr_b16 v[140:141], v7 offset:32
    ds_read_b64_tr_b16 v[142:143], v7 offset:10272
    ds_read_b64_tr_b16 v[144:145], v7 offset:288
    ds_read_b64_tr_b16 v[146:147], v7 offset:10528
    ds_read_b64_tr_b16 v[148:149], v7 offset:544
    ds_read_b64_tr_b16 v[150:151], v7 offset:10784
    ds_read_b64_tr_b16 v[152:153], v7 offset:800
    ds_read_b64_tr_b16 v[154:155], v7 offset:11040
    ds_read_b64_tr_b16 v[156:157], v7 offset:1056
    ds_read_b64_tr_b16 v[158:159], v7 offset:11296
    s_waitcnt lgkmcnt(0)
    s_add_u32 s13, s15, 1024
    buffer_store_dwordx4 v[120:123], v3, s[20:23], s13 offen sc0 sc1
    s_add_u32 s13, s15, 77824
    buffer_store_dwordx4 v[124:127], v3, s[20:23], s13 offen sc0 sc1
    s_add_u32 s13, s15, 154624
    buffer_store_dwordx4 v[128:131], v3, s[20:23], s13 offen sc0 sc1
    s_add_u32 s13, s15, 231424
    buffer_store_dwordx4 v[132:135], v3, s[20:23], s13 offen sc0 sc1
    s_add_u32 s13, s15, 308224
    buffer_store_dwordx4 v[136:139], v3, s[20:23], s13 offen sc0 sc1
    s_add_u32 s13, s15, 385024
    buffer_store_dwordx4 v[140:143], v3, s[20:23], s13 offen sc0 sc1
    s_add_u32 s13, s15, 461824
    buffer_store_dwordx4 v[144:147], v3, s[20:23], s13 offen sc0 sc1
    s_add_u32 s13, s15, 538624
    buffer_store_dwordx4 v[148:151], v3, s[20:23], s13 offen sc0 sc1
    s_add_u32 s13, s15, 615424
    buffer_store_dwordx4 v[152:155], v3, s[20:23], s13 offen sc0 sc1
    s_add_u32 s13, s15, 692224
    buffer_store_dwordx4 v[156:159], v3, s[20:23], s13 offen sc0 sc1
    s_endpgm
K2_END:
    s_endpgm
.globl k3_kernel
.p2align 8
.type k3_kernel,@function
k3_kernel:
    s_cmp_ge_u32 s2, 256
    s_cbranch_scc1 K3_END
    s_load_dwordx2 s[4:5], s[0:1], 0
    s_load_dwordx4 s[8:11], s[0:1], 56
    s_load_dwordx2 s[6:7], s[0:1], 80
    v_lshrrev_b32 v1, 6, v0
    v_and_b32 v2, 63, v0
    v_readfirstlane_b32 s3, v1
    s_and_b32 s12, s2, 7
    s_lshr_b32 s13, s2, 3
    s_lshr_b32 s14, s12, 1
    s_lshl_b32 s14, s14, 3
    s_lshr_b32 s15, s13, 2
    s_add_u32 s14, s14, s15
    s_and_b32 s12, s12, 1
    s_lshl_b32 s12, s12, 2
    s_and_b32 s13, s13, 3
    s_add_u32 s15, s12, s13
    v_lshlrev_b32 v3, 4, v2
    s_add_u32 s12, s3, 0
    s_and_b32 s12, s12, 3
    s_lshl_b32 s13, s14, 2
    s_add_u32 s12, s12, s13
    s_mul_i32 s12, s12, 76800
    v_add_u32 v4, s12, v3
    s_add_u32 s12, s3, 1
    s_and_b32 s12, s12, 3
    s_lshl_b32 s13, s14, 2
    s_add_u32 s12, s12, s13
    s_mul_i32 s12, s12, 76800
    v_add_u32 v5, s12, v3
    s_add_u32 s12, s3, 2
    s_and_b32 s12, s12, 3
    s_lshl_b32 s13, s14, 2
    s_add_u32 s12, s12, s13
    s_mul_i32 s12, s12, 76800
    v_add_u32 v6, s12, v3
    s_add_u32 s12, s3, 3
    s_and_b32 s12, s12, 3
    s_lshl_b32 s13, s14, 2
    s_add_u32 s12, s12, s13
    s_mul_i32 s12, s12, 76800
    v_add_u32 v7, s12, v3
    s_mul_i32 s12, s15, 384000
    v_add_u32 v8, s12, v3
    s_add_u32 s12, s12, 76800
    v_add_u32 v9, s12, v3
    s_add_u32 s12, s12, 76800
    v_add_u32 v10, s12, v3
    s_add_u32 s12, s12, 76800
    v_add_u32 v11, s12, v3
    s_add_u32 s12, s12, 76800
    v_add_u32 v12, s12, v3
    s_add_u32 s32, s3, 59
    s_lshl_b32 s32, s32, 10
    s_waitcnt lgkmcnt(0)
    s_add_u32 s16, s6, 0x900000
    s_addc_u32 s17, s7, 0
    s_mov_b32 s18, 0x960000
    s_mov_b32 s19, 0x00020000
    s_add_u32 s20, s6, 0x1300000
    s_addc_u32 s21, s7, 0
    s_mov_b32 s22, 0x2ee000
    s_mov_b32 s23, 0x00020000
    buffer_load_dwordx4 a[16:19], v8, s[20:23], s32 offen
    buffer_load_dwordx4 a[20:23], v9, s[20:23], s32 offen
    buffer_load_dwordx4 a[0:3], v4, s[16:19], s32 offen
    buffer_load_dwordx4 a[4:7], v5, s[16:19], s32 offen
    buffer_load_dwordx4 a[8:11], v6, s[16:19], s32 offen
    buffer_load_dwordx4 a[12:15], v7, s[16:19], s32 offen
    s_add_u32 s32, s32, 4096
    buffer_load_dwordx4 a[52:55], v8, s[20:23], s32 offen
    buffer_load_dwordx4 a[56:59], v9, s[20:23], s32 offen
    buffer_load_dwordx4 a[36:39], v4, s[16:19], s32 offen
    buffer_load_dwordx4 a[40:43], v5, s[16:19], s32 offen
    buffer_load_dwordx4 a[44:47], v6, s[16:19], s32 offen
    buffer_load_dwordx4 a[48:51], v7, s[16:19], s32 offen
    s_add_u32 s32, s32, 4096
    buffer_load_dwordx4 a[88:91], v8, s[20:23], s32 offen
    buffer_load_dwordx4 a[92:95], v9, s[20:23], s32 offen
    buffer_load_dwordx4 a[72:75], v4, s[16:19], s32 offen
    buffer_load_dwordx4 a[76:79], v5, s[16:19], s32 offen
    buffer_load_dwordx4 a[80:83], v6, s[16:19], s32 offen
    buffer_load_dwordx4 a[84:87], v7, s[16:19], s32 offen
    s_add_u32 s32, s32, 4096
    buffer_load_dwordx4 a[124:127], v8, s[20:23], s32 offen
    buffer_load_dwordx4 a[128:131], v9, s[20:23], s32 offen
    buffer_load_dwordx4 a[108:111], v4, s[16:19], s32 offen
    buffer_load_dwordx4 a[112:115], v5, s[16:19], s32 offen
    buffer_load_dwordx4 a[116:119], v6, s[16:19], s32 offen
    buffer_load_dwordx4 a[120:123], v7, s[16:19], s32 offen
    s_sub_u32 s32, s32, 16384
    buffer_load_dwordx4 a[160:163], v8, s[20:23], s32 offen
    buffer_load_dwordx4 a[144:147], v4, s[16:19], s32 offen
    buffer_load_dwordx4 a[148:151], v5, s[16:19], s32 offen
    buffer_load_dwordx4 a[152:155], v6, s[16:19], s32 offen
    buffer_load_dwordx4 a[156:159], v7, s[16:19], s32 offen
    s_sub_u32 s32, s32, 56320
    s_getpc_b64 s[46:47]
CPF6:
    s_add_u32 s46, s46, k3_kernel-CPF6
    s_addc_u32 s47, s47, (k3_kernel-CPF6)>>32
    v_lshlrev_b32 v240, 6, v0
    v_add_u32 v240, 0, v240
    v_min_u32 v240, K3_END-k3_kernel-4, v240
    v_mov_b32 v241, s47
    v_add_co_u32 v240, vcc, s46, v240
    v_addc_co_u32 v241, vcc, 0, v241, vcc
    global_load_dword v242, v[240:241], off
    s_mov_b32 s24, s4
    s_mov_b32 s25, s5
    s_mov_b32 s26, 0x280000
    s_mov_b32 s27, 0x00020000
    s_mov_b32 s28, s8
    s_mov_b32 s29, s9
    s_mov_b32 s30, 0x500
    s_mov_b32 s31, 0x00020000
    s_mov_b32 s36, s10
    s_mov_b32 s37, s11
    s_mov_b32 s38, 0x280000
    s_mov_b32 s39, 0x00020000
    s_lshl_b32 s12, s14, 2
    s_add_u32 s12, s12, s3
    s_lshl_b32 s12, s12, 4
    v_and_b32 v13, 15, v2
    v_add_u32 v13, s12, v13
    v_lshrrev_b32 v14, 5, v13
    v_and_b32 v13, 31, v13
    v_lshl_add_u32 v13, v13, 6, v14
    v_mul_u32_u24 v13, 1280, v13
    v_lshrrev_b32 v14, 4, v2
    v_lshlrev_b32 v14, 3, v14
    s_lshl_b32 s12, s15, 5
    v_add_u32 v14, s12, v14
    v_add_u32 v13, v13, v14
    s_add_u32 s12, s3, 1
    v_cvt_f32_u32 v15, s12
    v_mul_f32 v180, 0x00000000, v15
    v_mul_f32 v182, 0x3e4ccccd, v15
    v_mul_f32 v184, 0x3ecccccd, v15
    v_mul_f32 v186, 0x3f19999a, v15
    v_mul_f32 v188, 0x3f4ccccd, v15
    v_sin_f32 v190, -v180
    v_cos_f32 v180, v180
    v_sin_f32 v192, -v182
    v_cos_f32 v182, v182
    v_sin_f32 v194, -v184
    v_cos_f32 v184, v184
    v_sin_f32 v196, -v186
    v_cos_f32 v186, v186
    v_sin_f32 v198, -v188
    v_cos_f32 v188, v188
    s_nop 0
    v_mov_b32 v181, v180
    v_mov_b32 v183, v182
    v_mov_b32 v185, v184
    v_mov_b32 v187, v186
    v_mov_b32 v189, v188
    v_mov_b32 v191, v190
    v_mov_b32 v193, v192
    v_mov_b32 v195, v194
    v_mov_b32 v197, v196
    v_mov_b32 v199, v198
    s_waitcnt vmcnt(24)
    v_mfma_f32_16x16x32_bf16 v[200:203], a[16:19], a[0:3], 0
    buffer_load_dwordx4 a[196:199], v8, s[20:23], s32 offen
    buffer_load_dwordx4 a[200:203], v9, s[20:23], s32 offen
    v_mfma_f32_16x16x32_bf16 v[204:207], a[16:19], a[4:7], 0
    buffer_load_dwordx4 a[204:207], v10, s[20:23], s32 offen
    v_mfma_f32_16x16x32_bf16 v[208:211], a[16:19], a[8:11], 0
    buffer_load_dwordx4 a[208:211], v11, s[20:23], s32 offen
    v_mfma_f32_16x16x32_bf16 v[212:215], a[16:19], a[12:15], 0
    buffer_load_dwordx4 a[212:215], v12, s[20:23], s32 offen
    v_mfma_f32_16x16x32_bf16 v[216:219], a[20:23], a[0:3], 0
    buffer_load_dwordx4 a[180:183], v4, s[16:19], s32 offen
    v_mfma_f32_16x16x32_bf16 v[220:223], a[20:23], a[4:7], 0
    buffer_load_dwordx4 a[184:187], v5, s[16:19], s32 offen
    v_mfma_f32_16x16x32_bf16 v[224:227], a[20:23], a[8:11], 0
    buffer_load_dwordx4 a[188:191], v6, s[16:19], s32 offen
    v_mfma_f32_16x16x32_bf16 v[228:231], a[20:23], a[12:15], 0
    buffer_load_dwordx4 a[192:195], v7, s[16:19], s32 offen
    s_add_u32 s32, s32, 4096
    s_waitcnt vmcnt(27)
    v_mfma_f32_16x16x32_bf16 v[200:203], a[52:55], a[36:39], v[200:203]
    buffer_load_dwordx4 a[16:19], v8, s[20:23], s32 offen
    buffer_load_dwordx4 a[20:23], v9, s[20:23], s32 offen
    v_mfma_f32_16x16x32_bf16 v[204:207], a[52:55], a[40:43], v[204:207]
    buffer_load_dwordx4 a[24:27], v10, s[20:23], s32 offen
    v_mfma_f32_16x16x32_bf16 v[208:211], a[52:55], a[44:47], v[208:211]
    buffer_load_dwordx4 a[28:31], v11, s[20:23], s32 offen
    v_mfma_f32_16x16x32_bf16 v[212:215], a[52:55], a[48:51], v[212:215]
    buffer_load_dwordx4 a[32:35], v12, s[20:23], s32 offen
    v_mfma_f32_16x16x32_bf16 v[216:219], a[56:59], a[36:39], v[216:219]
    buffer_load_dwordx4 a[0:3], v4, s[16:19], s32 offen
    v_mfma_f32_16x16x32_bf16 v[220:223], a[56:59], a[40:43], v[220:223]
    buffer_load_dwordx4 a[4:7], v5, s[16:19], s32 offen
    v_mfma_f32_16x16x32_bf16 v[224:227], a[56:59], a[44:47], v[224:227]
    buffer_load_dwordx4 a[8:11], v6, s[16:19], s32 offen
    v_mfma_f32_16x16x32_bf16 v[228:231], a[56:59], a[48:51], v[228:231]
    buffer_load_dwordx4 a[12:15], v7, s[16:19], s32 offen
    s_add_u32 s32, s32, 4096
    s_waitcnt vmcnt(30)
    v_mfma_f32_16x16x32_bf16 v[200:203], a[88:91], a[72:75], v[200:203]
    buffer_load_dwordx4 a[52:55], v8, s[20:23], s32 offen
    buffer_load_dwordx4 a[56:59], v9, s[20:23], s32 offen
    v_mfma_f32_16x16x32_bf16 v[204:207], a[88:91], a[76:79], v[204:207]
    buffer_load_dwordx4 a[60:63], v10, s[20:23], s32 offen
    v_mfma_f32_16x16x32_bf16 v[208:211], a[88:91], a[80:83], v[208:211]
    buffer_load_dwordx4 a[64:67], v11, s[20:23], s32 offen
    v_mfma_f32_16x16x32_bf16 v[212:215], a[88:91], a[84:87], v[212:215]
    buffer_load_dwordx4 a[68:71], v12, s[20:23], s32 offen
    v_mfma_f32_16x16x32_bf16 v[216:219], a[92:95], a[72:75], v[216:219]
    buffer_load_dwordx4 a[36:39], v4, s[16:19], s32 offen
    v_mfma_f32_16x16x32_bf16 v[220:223], a[92:95], a[76:79], v[220:223]
    buffer_load_dwordx4 a[40:43], v5, s[16:19], s32 offen
    v_mfma_f32_16x16x32_bf16 v[224:227], a[92:95], a[80:83], v[224:227]
    buffer_load_dwordx4 a[44:47], v6, s[16:19], s32 offen
    v_mfma_f32_16x16x32_bf16 v[228:231], a[92:95], a[84:87], v[228:231]
    buffer_load_dwordx4 a[48:51], v7, s[16:19], s32 offen
    s_add_u32 s32, s32, 4096
    s_waitcnt vmcnt(33)
    v_mfma_f32_16x16x32_bf16 v[200:203], a[124:127], a[108:111], v[200:203]
    buffer_load_dwordx4 a[88:91], v8, s[20:23], s32 offen
    buffer_load_dwordx4 a[92:95], v9, s[20:23], s32 offen
    v_mfma_f32_16x16x32_bf16 v[204:207], a[124:127], a[112:115], v[204:207]
    buffer_load_dwordx4 a[96:99], v10, s[20:23], s32 offen
    v_mfma_f32_16x16x32_bf16 v[208:211], a[124:127], a[116:119], v[208:211]
    buffer_load_dwordx4 a[100:103], v11, s[20:23], s32 offen
    v_mfma_f32_16x16x32_bf16 v[212:215], a[124:127], a[120:123], v[212:215]
    buffer_load_dwordx4 a[104:107], v12, s[20:23], s32 offen
    v_mfma_f32_16x16x32_bf16 v[216:219], a[128:131], a[108:111], v[216:219]
    buffer_load_dwordx4 a[72:75], v4, s[16:19], s32 offen
    v_mfma_f32_16x16x32_bf16 v[220:223], a[128:131], a[112:115], v[220:223]
    buffer_load_dwordx4 a[76:79], v5, s[16:19], s32 offen
    v_mfma_f32_16x16x32_bf16 v[224:227], a[128:131], a[116:119], v[224:227]
    buffer_load_dwordx4 a[80:83], v6, s[16:19], s32 offen
    v_mfma_f32_16x16x32_bf16 v[228:231], a[128:131], a[120:123], v[228:231]
    buffer_load_dwordx4 a[84:87], v7, s[16:19], s32 offen
    s_add_u32 s32, s32, 4096
    s_nop 7
    s_nop 3
    v_pk_mul_f32 v[16:17], v[200:201], v[180:181]
    v_pk_mul_f32 v[18:19], v[202:203], v[180:181]
    v_pk_mul_f32 v[36:37], v[204:205], v[180:181]
    v_pk_mul_f32 v[38:39], v[206:207], v[180:181]
    v_pk_mul_f32 v[56:57], v[208:209], v[180:181]
    v_pk_mul_f32 v[58:59], v[210:211], v[180:181]
    v_pk_mul_f32 v[76:77], v[212:213], v[180:181]
    v_pk_mul_f32 v[78:79], v[214:215], v[180:181]
    v_pk_fma_f32 v[16:17], v[216:217], v[190:191], v[16:17]
    v_pk_fma_f32 v[18:19], v[218:219], v[190:191], v[18:19]
    v_pk_fma_f32 v[36:37], v[220:221], v[190:191], v[36:37]
    v_pk_fma_f32 v[38:39], v[222:223], v[190:191], v[38:39]
    v_pk_fma_f32 v[56:57], v[224:225], v[190:191], v[56:57]
    v_pk_fma_f32 v[58:59], v[226:227], v[190:191], v[58:59]
    v_pk_fma_f32 v[76:77], v[228:229], v[190:191], v[76:77]
    v_pk_fma_f32 v[78:79], v[230:231], v[190:191], v[78:79]
    v_pk_mul_f32 v[20:21], v[200:201], v[182:183]
    v_pk_mul_f32 v[22:23], v[202:203], v[182:183]
    v_pk_mul_f32 v[40:41], v[204:205], v[182:183]
    v_pk_mul_f32 v[42:43], v[206:207], v[182:183]
    v_pk_mul_f32 v[60:61], v[208:209], v[182:183]
    v_pk_mul_f32 v[62:63], v[210:211], v[182:183]
    v_pk_mul_f32 v[80:81], v[212:213], v[182:183]
    v_pk_mul_f32 v[82:83], v[214:215], v[182:183]
    v_pk_fma_f32 v[20:21], v[216:217], v[192:193], v[20:21]
    v_pk_fma_f32 v[22:23], v[218:219], v[192:193], v[22:23]
    v_pk_fma_f32 v[40:41], v[220:221], v[192:193], v[40:41]
    v_pk_fma_f32 v[42:43], v[222:223], v[192:193], v[42:43]
    v_pk_fma_f32 v[60:61], v[224:225], v[192:193], v[60:61]
    v_pk_fma_f32 v[62:63], v[226:227], v[192:193], v[62:63]
    v_pk_fma_f32 v[80:81], v[228:229], v[192:193], v[80:81]
    v_pk_fma_f32 v[82:83], v[230:231], v[192:193], v[82:83]
    v_pk_mul_f32 v[24:25], v[200:201], v[184:185]
    v_pk_mul_f32 v[26:27], v[202:203], v[184:185]
    v_pk_mul_f32 v[44:45], v[204:205], v[184:185]
    v_pk_mul_f32 v[46:47], v[206:207], v[184:185]
    v_pk_mul_f32 v[64:65], v[208:209], v[184:185]
    v_pk_mul_f32 v[66:67], v[210:211], v[184:185]
    v_pk_mul_f32 v[84:85], v[212:213], v[184:185]
    v_pk_mul_f32 v[86:87], v[214:215], v[184:185]
    v_pk_fma_f32 v[24:25], v[216:217], v[194:195], v[24:25]
    v_pk_fma_f32 v[26:27], v[218:219], v[194:195], v[26:27]
    v_pk_fma_f32 v[44:45], v[220:221], v[194:195], v[44:45]
    v_pk_fma_f32 v[46:47], v[222:223], v[194:195], v[46:47]
    v_pk_fma_f32 v[64:65], v[224:225], v[194:195], v[64:65]
    v_pk_fma_f32 v[66:67], v[226:227], v[194:195], v[66:67]
    v_pk_fma_f32 v[84:85], v[228:229], v[194:195], v[84:85]
    v_pk_fma_f32 v[86:87], v[230:231], v[194:195], v[86:87]
    v_pk_mul_f32 v[28:29], v[200:201], v[186:187]
    v_pk_mul_f32 v[30:31], v[202:203], v[186:187]
    v_pk_mul_f32 v[48:49], v[204:205], v[186:187]
    v_pk_mul_f32 v[50:51], v[206:207], v[186:187]
    v_pk_mul_f32 v[68:69], v[208:209], v[186:187]
    v_pk_mul_f32 v[70:71], v[210:211], v[186:187]
    v_pk_mul_f32 v[88:89], v[212:213], v[186:187]
    v_pk_mul_f32 v[90:91], v[214:215], v[186:187]
    v_pk_fma_f32 v[28:29], v[216:217], v[196:197], v[28:29]
    v_pk_fma_f32 v[30:31], v[218:219], v[196:197], v[30:31]
    v_pk_fma_f32 v[48:49], v[220:221], v[196:197], v[48:49]
    v_pk_fma_f32 v[50:51], v[222:223], v[196:197], v[50:51]
    v_pk_fma_f32 v[68:69], v[224:225], v[196:197], v[68:69]
    v_pk_fma_f32 v[70:71], v[226:227], v[196:197], v[70:71]
    v_pk_fma_f32 v[88:89], v[228:229], v[196:197], v[88:89]
    v_pk_fma_f32 v[90:91], v[230:231], v[196:197], v[90:91]
    v_pk_mul_f32 v[32:33], v[200:201], v[188:189]
    v_pk_mul_f32 v[34:35], v[202:203], v[188:189]
    v_pk_mul_f32 v[52:53], v[204:205], v[188:189]
    v_pk_mul_f32 v[54:55], v[206:207], v[188:189]
    v_pk_mul_f32 v[72:73], v[208:209], v[188:189]
    v_pk_mul_f32 v[74:75], v[210:211], v[188:189]
    v_pk_mul_f32 v[92:93], v[212:213], v[188:189]
    v_pk_mul_f32 v[94:95], v[214:215], v[188:189]
    v_pk_fma_f32 v[32:33], v[216:217], v[198:199], v[32:33]
    v_pk_fma_f32 v[34:35], v[218:219], v[198:199], v[34:35]
    v_pk_fma_f32 v[52:53], v[220:221], v[198:199], v[52:53]
    v_pk_fma_f32 v[54:55], v[222:223], v[198:199], v[54:55]
    v_pk_fma_f32 v[72:73], v[224:225], v[198:199], v[72:73]
    v_pk_fma_f32 v[74:75], v[226:227], v[198:199], v[74:75]
    v_pk_fma_f32 v[92:93], v[228:229], v[198:199], v[92:93]
    v_pk_fma_f32 v[94:95], v[230:231], v[198:199], v[94:95]
    s_nop 1
    s_waitcnt vmcnt(37)
    v_mfma_f32_16x16x32_bf16 v[16:19], a[160:163], a[144:147], v[16:19]
    buffer_load_dwordx4 a[124:127], v8, s[20:23], s32 offen
    v_mfma_f32_16x16x32_bf16 v[36:39], a[160:163], a[148:151], v[36:39]
    v_mfma_f32_16x16x32_bf16 v[56:59], a[160:163], a[152:155], v[56:59]
    buffer_load_dwordx4 a[128:131], v9, s[20:23], s32 offen
    v_mfma_f32_16x16x32_bf16 v[76:79], a[160:163], a[156:159], v[76:79]
    v_mfma_f32_16x16x32_bf16 v[20:23], a[160:163], a[144:147], v[20:23]
    buffer_load_dwordx4 a[132:135], v10, s[20:23], s32 offen
    v_mfma_f32_16x16x32_bf16 v[40:43], a[160:163], a[148:151], v[40:43]
    v_mfma_f32_16x16x32_bf16 v[60:63], a[160:163], a[152:155], v[60:63]
    buffer_load_dwordx4 a[136:139], v11, s[20:23], s32 offen
    v_mfma_f32_16x16x32_bf16 v[80:83], a[160:163], a[156:159], v[80:83]
    v_mfma_f32_16x16x32_bf16 v[24:27], a[160:163], a[144:147], v[24:27]
    buffer_load_dwordx4 a[140:143], v12, s[20:23], s32 offen
    v_mfma_f32_16x16x32_bf16 v[44:47], a[160:163], a[148:151], v[44:47]
    v_mfma_f32_16x16x32_bf16 v[64:67], a[160:163], a[152:155], v[64:67]
    buffer_load_dwordx4 a[108:111], v4, s[16:19], s32 offen
    v_mfma_f32_16x16x32_bf16 v[84:87], a[160:163], a[156:159], v[84:87]
    v_mfma_f32_16x16x32_bf16 v[28:31], a[160:163], a[144:147], v[28:31]
    buffer_load_dwordx4 a[112:115], v5, s[16:19], s32 offen
    v_mfma_f32_16x16x32_bf16 v[48:51], a[160:163], a[148:151], v[48:51]
    v_mfma_f32_16x16x32_bf16 v[68:71], a[160:163], a[152:155], v[68:71]
    buffer_load_dwordx4 a[116:119], v6, s[16:19], s32 offen
    v_mfma_f32_16x16x32_bf16 v[88:91], a[160:163], a[156:159], v[88:91]
    v_mfma_f32_16x16x32_bf16 v[32:35], a[160:163], a[144:147], v[32:35]
    buffer_load_dwordx4 a[120:123], v7, s[16:19], s32 offen
    s_add_u32 s32, s32, 4096
    v_mfma_f32_16x16x32_bf16 v[52:55], a[160:163], a[148:151], v[52:55]
    v_mfma_f32_16x16x32_bf16 v[72:75], a[160:163], a[152:155], v[72:75]
    v_mfma_f32_16x16x32_bf16 v[92:95], a[160:163], a[156:159], v[92:95]
    s_waitcnt vmcnt(36)
    v_mfma_f32_16x16x32_bf16 v[16:19], a[196:199], a[180:183], v[16:19]
    buffer_load_dwordx4 a[160:163], v8, s[20:23], s32 offen
    v_mfma_f32_16x16x32_bf16 v[36:39], a[196:199], a[184:187], v[36:39]
    v_mfma_f32_16x16x32_bf16 v[56:59], a[196:199], a[188:191], v[56:59]
    buffer_load_dwordx4 a[164:167], v9, s[20:23], s32 offen
    v_mfma_f32_16x16x32_bf16 v[76:79], a[196:199], a[192:195], v[76:79]
    v_mfma_f32_16x16x32_bf16 v[20:23], a[200:203], a[180:183], v[20:23]
    buffer_load_dwordx4 a[168:171], v10, s[20:23], s32 offen
    v_mfma_f32_16x16x32_bf16 v[40:43], a[200:203], a[184:187], v[40:43]
    v_mfma_f32_16x16x32_bf16 v[60:63], a[200:203], a[188:191], v[60:63]
    buffer_load_dwordx4 a[172:175], v11, s[20:23], s32 offen
    v_mfma_f32_16x16x32_bf16 v[80:83], a[200:203], a[192:195], v[80:83]
    v_mfma_f32_16x16x32_bf16 v[24:27], a[204:207], a[180:183], v[24:27]
    buffer_load_dwordx4 a[176:179], v12, s[20:23], s32 offen
    v_mfma_f32_16x16x32_bf16 v[44:47], a[204:207], a[184:187], v[44:47]
    v_mfma_f32_16x16x32_bf16 v[64:67], a[204:207], a[188:191], v[64:67]
    buffer_load_dwordx4 a[144:147], v4, s[16:19], s32 offen
    v_mfma_f32_16x16x32_bf16 v[84:87], a[204:207], a[192:195], v[84:87]
    v_mfma_f32_16x16x32_bf16 v[28:31], a[208:211], a[180:183], v[28:31]
    buffer_load_dwordx4 a[148:151], v5, s[16:19], s32 offen
    v_mfma_f32_16x16x32_bf16 v[48:51], a[208:211], a[184:187], v[48:51]
    v_mfma_f32_16x16x32_bf16 v[68:71], a[208:211], a[188:191], v[68:71]
    buffer_load_dwordx4 a[152:155], v6, s[16:19], s32 offen
    v_mfma_f32_16x16x32_bf16 v[88:91], a[208:211], a[192:195], v[88:91]
    v_mfma_f32_16x16x32_bf16 v[32:35], a[212:215], a[180:183], v[32:35]
    buffer_load_dwordx4 a[156:159], v7, s[16:19], s32 offen
    s_add_u32 s32, s32, 4096
    v_mfma_f32_16x16x32_bf16 v[52:55], a[212:215], a[184:187], v[52:55]
    v_mfma_f32_16x16x32_bf16 v[72:75], a[212:215], a[188:191], v[72:75]
    v_mfma_f32_16x16x32_bf16 v[92:95], a[212:215], a[192:195], v[92:95]
    s_waitcnt vmcnt(36)
    v_mfma_f32_16x16x32_bf16 v[16:19], a[16:19], a[0:3], v[16:19]
    buffer_load_dwordx4 a[196:199], v8, s[20:23], s32 offen
    v_mfma_f32_16x16x32_bf16 v[36:39], a[16:19], a[4:7], v[36:39]
    v_mfma_f32_16x16x32_bf16 v[56:59], a[16:19], a[8:11], v[56:59]
    buffer_load_dwordx4 a[200:203], v9, s[20:23], s32 offen
    v_mfma_f32_16x16x32_bf16 v[76:79], a[16:19], a[12:15], v[76:79]
    v_mfma_f32_16x16x32_bf16 v[20:23], a[20:23], a[0:3], v[20:23]
    buffer_load_dwordx4 a[204:207], v10, s[20:23], s32 offen
    v_mfma_f32_16x16x32_bf16 v[40:43], a[20:23], a[4:7], v[40:43]
    v_mfma_f32_16x16x32_bf16 v[60:63], a[20:23], a[8:11], v[60:63]
    buffer_load_dwordx4 a[208:211], v11, s[20:23], s32 offen
    v_mfma_f32_16x16x32_bf16 v[80:83], a[20:23], a[12:15], v[80:83]
    v_mfma_f32_16x16x32_bf16 v[24:27], a[24:27], a[0:3], v[24:27]
    buffer_load_dwordx4 a[212:215], v12, s[20:23], s32 offen
    v_mfma_f32_16x16x32_bf16 v[44:47], a[24:27], a[4:7], v[44:47]
    v_mfma_f32_16x16x32_bf16 v[64:67], a[24:27], a[8:11], v[64:67]
    buffer_load_dwordx4 a[180:183], v4, s[16:19], s32 offen
    v_mfma_f32_16x16x32_bf16 v[84:87], a[24:27], a[12:15], v[84:87]
    v_mfma_f32_16x16x32_bf16 v[28:31], a[28:31], a[0:3], v[28:31]
    buffer_load_dwordx4 a[184:187], v5, s[16:19], s32 offen
    v_mfma_f32_16x16x32_bf16 v[48:51], a[28:31], a[4:7], v[48:51]
    v_mfma_f32_16x16x32_bf16 v[68:71], a[28:31], a[8:11], v[68:71]
    buffer_load_dwordx4 a[188:191], v6, s[16:19], s32 offen
    v_mfma_f32_16x16x32_bf16 v[88:91], a[28:31], a[12:15], v[88:91]
    v_mfma_f32_16x16x32_bf16 v[32:35], a[32:35], a[0:3], v[32:35]
    buffer_load_dwordx4 a[192:195], v7, s[16:19], s32 offen
    s_add_u32 s32, s32, 4096
    v_mfma_f32_16x16x32_bf16 v[52:55], a[32:35], a[4:7], v[52:55]
    v_mfma_f32_16x16x32_bf16 v[72:75], a[32:35], a[8:11], v[72:75]
    v_mfma_f32_16x16x32_bf16 v[92:95], a[32:35], a[12:15], v[92:95]
    s_waitcnt vmcnt(36)
    v_mfma_f32_16x16x32_bf16 v[16:19], a[52:55], a[36:39], v[16:19]
    buffer_load_dwordx4 a[16:19], v8, s[20:23], s32 offen
    v_mfma_f32_16x16x32_bf16 v[36:39], a[52:55], a[40:43], v[36:39]
    v_mfma_f32_16x16x32_bf16 v[56:59], a[52:55], a[44:47], v[56:59]
    buffer_load_dwordx4 a[20:23], v9, s[20:23], s32 offen
    v_mfma_f32_16x16x32_bf16 v[76:79], a[52:55], a[48:51], v[76:79]
    v_mfma_f32_16x16x32_bf16 v[20:23], a[56:59], a[36:39], v[20:23]
    buffer_load_dwordx4 a[24:27], v10, s[20:23], s32 offen
    v_mfma_f32_16x16x32_bf16 v[40:43], a[56:59], a[40:43], v[40:43]
    v_mfma_f32_16x16x32_bf16 v[60:63], a[56:59], a[44:47], v[60:63]
    buffer_load_dwordx4 a[28:31], v11, s[20:23], s32 offen
    v_mfma_f32_16x16x32_bf16 v[80:83], a[56:59], a[48:51], v[80:83]
    v_mfma_f32_16x16x32_bf16 v[24:27], a[60:63], a[36:39], v[24:27]
    buffer_load_dwordx4 a[32:35], v12, s[20:23], s32 offen
    v_mfma_f32_16x16x32_bf16 v[44:47], a[60:63], a[40:43], v[44:47]
    v_mfma_f32_16x16x32_bf16 v[64:67], a[60:63], a[44:47], v[64:67]
    buffer_load_dwordx4 a[0:3], v4, s[16:19], s32 offen
    v_mfma_f32_16x16x32_bf16 v[84:87], a[60:63], a[48:51], v[84:87]
    v_mfma_f32_16x16x32_bf16 v[28:31], a[64:67], a[36:39], v[28:31]
    buffer_load_dwordx4 a[4:7], v5, s[16:19], s32 offen
    v_mfma_f32_16x16x32_bf16 v[48:51], a[64:67], a[40:43], v[48:51]
    v_mfma_f32_16x16x32_bf16 v[68:71], a[64:67], a[44:47], v[68:71]
    buffer_load_dwordx4 a[8:11], v6, s[16:19], s32 offen
    v_mfma_f32_16x16x32_bf16 v[88:91], a[64:67], a[48:51], v[88:91]
    v_mfma_f32_16x16x32_bf16 v[32:35], a[68:71], a[36:39], v[32:35]
    buffer_load_dwordx4 a[12:15], v7, s[16:19], s32 offen
    s_add_u32 s32, s32, 4096
    v_mfma_f32_16x16x32_bf16 v[52:55], a[68:71], a[40:43], v[52:55]
    v_mfma_f32_16x16x32_bf16 v[72:75], a[68:71], a[44:47], v[72:75]
    v_mfma_f32_16x16x32_bf16 v[92:95], a[68:71], a[48:51], v[92:95]
    s_waitcnt vmcnt(36)
    v_mfma_f32_16x16x32_bf16 v[16:19], a[88:91], a[72:75], v[16:19]
    buffer_load_dwordx4 a[52:55], v8, s[20:23], s32 offen
    v_mfma_f32_16x16x32_bf16 v[36:39], a[88:91], a[76:79], v[36:39]
    v_mfma_f32_16x16x32_bf16 v[56:59], a[88:91], a[80:83], v[56:59]
    buffer_load_dwordx4 a[56:59], v9, s[20:23], s32 offen
    v_mfma_f32_16x16x32_bf16 v[76:79], a[88:91], a[84:87], v[76:79]
    v_mfma_f32_16x16x32_bf16 v[20:23], a[92:95], a[72:75], v[20:23]
    buffer_load_dwordx4 a[60:63], v10, s[20:23], s32 offen
    v_mfma_f32_16x16x32_bf16 v[40:43], a[92:95], a[76:79], v[40:43]
    v_mfma_f32_16x16x32_bf16 v[60:63], a[92:95], a[80:83], v[60:63]
    buffer_load_dwordx4 a[64:67], v11, s[20:23], s32 offen
    v_mfma_f32_16x16x32_bf16 v[80:83], a[92:95], a[84:87], v[80:83]
    v_mfma_f32_16x16x32_bf16 v[24:27], a[96:99], a[72:75], v[24:27]
    buffer_load_dwordx4 a[68:71], v12, s[20:23], s32 offen
    v_mfma_f32_16x16x32_bf16 v[44:47], a[96:99], a[76:79], v[44:47]
    v_mfma_f32_16x16x32_bf16 v[64:67], a[96:99], a[80:83], v[64:67]
    buffer_load_dwordx4 a[36:39], v4, s[16:19], s32 offen
    v_mfma_f32_16x16x32_bf16 v[84:87], a[96:99], a[84:87], v[84:87]
    v_mfma_f32_16x16x32_bf16 v[28:31], a[100:103], a[72:75], v[28:31]
    buffer_load_dwordx4 a[40:43], v5, s[16:19], s32 offen
    v_mfma_f32_16x16x32_bf16 v[48:51], a[100:103], a[76:79], v[48:51]
    v_mfma_f32_16x16x32_bf16 v[68:71], a[100:103], a[80:83], v[68:71]
    buffer_load_dwordx4 a[44:47], v6, s[16:19], s32 offen
    v_mfma_f32_16x16x32_bf16 v[88:91], a[100:103], a[84:87], v[88:91]
    v_mfma_f32_16x16x32_bf16 v[32:35], a[104:107], a[72:75], v[32:35]
    buffer_load_dwordx4 a[48:51], v7, s[16:19], s32 offen
    s_add_u32 s32, s32, 4096
    v_mfma_f32_16x16x32_bf16 v[52:55], a[104:107], a[76:79], v[52:55]
    v_mfma_f32_16x16x32_bf16 v[72:75], a[104:107], a[80:83], v[72:75]
    v_mfma_f32_16x16x32_bf16 v[92:95], a[104:107], a[84:87], v[92:95]
    s_waitcnt vmcnt(36)
    v_mfma_f32_16x16x32_bf16 v[16:19], a[124:127], a[108:111], v[16:19]
    buffer_load_dwordx4 a[88:91], v8, s[20:23], s32 offen
    v_mfma_f32_16x16x32_bf16 v[36:39], a[124:127], a[112:115], v[36:39]
    v_mfma_f32_16x16x32_bf16 v[56:59], a[124:127], a[116:119], v[56:59]
    buffer_load_dwordx4 a[92:95], v9, s[20:23], s32 offen
    v_mfma_f32_16x16x32_bf16 v[76:79], a[124:127], a[120:123], v[76:79]
    v_mfma_f32_16x16x32_bf16 v[20:23], a[128:131], a[108:111], v[20:23]
    buffer_load_dwordx4 a[96:99], v10, s[20:23], s32 offen
    v_mfma_f32_16x16x32_bf16 v[40:43], a[128:131], a[112:115], v[40:43]
    v_mfma_f32_16x16x32_bf16 v[60:63], a[128:131], a[116:119], v[60:63]
    buffer_load_dwordx4 a[100:103], v11, s[20:23], s32 offen
    v_mfma_f32_16x16x32_bf16 v[80:83], a[128:131], a[120:123], v[80:83]
    v_mfma_f32_16x16x32_bf16 v[24:27], a[132:135], a[108:111], v[24:27]
    buffer_load_dwordx4 a[104:107], v12, s[20:23], s32 offen
    v_mfma_f32_16x16x32_bf16 v[44:47], a[132:135], a[112:115], v[44:47]
    v_mfma_f32_16x16x32_bf16 v[64:67], a[132:135], a[116:119], v[64:67]
    buffer_load_dwordx4 a[72:75], v4, s[16:19], s32 offen
    v_mfma_f32_16x16x32_bf16 v[84:87], a[132:135], a[120:123], v[84:87]
    v_mfma_f32_16x16x32_bf16 v[28:31], a[136:139], a[108:111], v[28:31]
    buffer_load_dwordx4 a[76:79], v5, s[16:19], s32 offen
    v_mfma_f32_16x16x32_bf16 v[48:51], a[136:139], a[112:115], v[48:51]
    v_mfma_f32_16x16x32_bf16 v[68:71], a[136:139], a[116:119], v[68:71]
    buffer_load_dwordx4 a[80:83], v6, s[16:19], s32 offen
    v_mfma_f32_16x16x32_bf16 v[88:91], a[136:139], a[120:123], v[88:91]
    v_mfma_f32_16x16x32_bf16 v[32:35], a[140:143], a[108:111], v[32:35]
    buffer_load_dwordx4 a[84:87], v7, s[16:19], s32 offen
    s_add_u32 s32, s32, 4096
    v_mfma_f32_16x16x32_bf16 v[52:55], a[140:143], a[112:115], v[52:55]
    v_mfma_f32_16x16x32_bf16 v[72:75], a[140:143], a[116:119], v[72:75]
    v_mfma_f32_16x16x32_bf16 v[92:95], a[140:143], a[120:123], v[92:95]
    s_waitcnt vmcnt(36)
    v_mfma_f32_16x16x32_bf16 v[16:19], a[160:163], a[144:147], v[16:19]
    buffer_load_dwordx4 a[124:127], v8, s[20:23], s32 offen
    v_mfma_f32_16x16x32_bf16 v[36:39], a[160:163], a[148:151], v[36:39]
    v_mfma_f32_16x16x32_bf16 v[56:59], a[160:163], a[152:155], v[56:59]
    buffer_load_dwordx4 a[128:131], v9, s[20:23], s32 offen
    v_mfma_f32_16x16x32_bf16 v[76:79], a[160:163], a[156:159], v[76:79]
    v_mfma_f32_16x16x32_bf16 v[20:23], a[164:167], a[144:147], v[20:23]
    buffer_load_dwordx4 a[132:135], v10, s[20:23], s32 offen
    v_mfma_f32_16x16x32_bf16 v[40:43], a[164:167], a[148:151], v[40:43]
    v_mfma_f32_16x16x32_bf16 v[60:63], a[164:167], a[152:155], v[60:63]
    buffer_load_dwordx4 a[136:139], v11, s[20:23], s32 offen
    v_mfma_f32_16x16x32_bf16 v[80:83], a[164:167], a[156:159], v[80:83]
    v_mfma_f32_16x16x32_bf16 v[24:27], a[168:171], a[144:147], v[24:27]
    buffer_load_dwordx4 a[140:143], v12, s[20:23], s32 offen
    v_mfma_f32_16x16x32_bf16 v[44:47], a[168:171], a[148:151], v[44:47]
    v_mfma_f32_16x16x32_bf16 v[64:67], a[168:171], a[152:155], v[64:67]
    buffer_load_dwordx4 a[108:111], v4, s[16:19], s32 offen
    v_mfma_f32_16x16x32_bf16 v[84:87], a[168:171], a[156:159], v[84:87]
    v_mfma_f32_16x16x32_bf16 v[28:31], a[172:175], a[144:147], v[28:31]
    buffer_load_dwordx4 a[112:115], v5, s[16:19], s32 offen
    v_mfma_f32_16x16x32_bf16 v[48:51], a[172:175], a[148:151], v[48:51]
    v_mfma_f32_16x16x32_bf16 v[68:71], a[172:175], a[152:155], v[68:71]
    buffer_load_dwordx4 a[116:119], v6, s[16:19], s32 offen
    v_mfma_f32_16x16x32_bf16 v[88:91], a[172:175], a[156:159], v[88:91]
    v_mfma_f32_16x16x32_bf16 v[32:35], a[176:179], a[144:147], v[32:35]
    buffer_load_dwordx4 a[120:123], v7, s[16:19], s32 offen
    s_add_u32 s32, s32, 4096
    v_mfma_f32_16x16x32_bf16 v[52:55], a[176:179], a[148:151], v[52:55]
    v_mfma_f32_16x16x32_bf16 v[72:75], a[176:179], a[152:155], v[72:75]
    v_mfma_f32_16x16x32_bf16 v[92:95], a[176:179], a[156:159], v[92:95]
    s_waitcnt vmcnt(36)
    v_mfma_f32_16x16x32_bf16 v[16:19], a[196:199], a[180:183], v[16:19]
    buffer_load_dwordx4 a[160:163], v8, s[20:23], s32 offen
    v_mfma_f32_16x16x32_bf16 v[36:39], a[196:199], a[184:187], v[36:39]
    v_mfma_f32_16x16x32_bf16 v[56:59], a[196:199], a[188:191], v[56:59]
    buffer_load_dwordx4 a[164:167], v9, s[20:23], s32 offen
    v_mfma_f32_16x16x32_bf16 v[76:79], a[196:199], a[192:195], v[76:79]
    v_mfma_f32_16x16x32_bf16 v[20:23], a[200:203], a[180:183], v[20:23]
    buffer_load_dwordx4 a[168:171], v10, s[20:23], s32 offen
    v_mfma_f32_16x16x32_bf16 v[40:43], a[200:203], a[184:187], v[40:43]
    v_mfma_f32_16x16x32_bf16 v[60:63], a[200:203], a[188:191], v[60:63]
    buffer_load_dwordx4 a[172:175], v11, s[20:23], s32 offen
    v_mfma_f32_16x16x32_bf16 v[80:83], a[200:203], a[192:195], v[80:83]
    v_mfma_f32_16x16x32_bf16 v[24:27], a[204:207], a[180:183], v[24:27]
    buffer_load_dwordx4 a[176:179], v12, s[20:23], s32 offen
    v_mfma_f32_16x16x32_bf16 v[44:47], a[204:207], a[184:187], v[44:47]
    v_mfma_f32_16x16x32_bf16 v[64:67], a[204:207], a[188:191], v[64:67]
    buffer_load_dwordx4 a[144:147], v4, s[16:19], s32 offen
    v_mfma_f32_16x16x32_bf16 v[84:87], a[204:207], a[192:195], v[84:87]
    v_mfma_f32_16x16x32_bf16 v[28:31], a[208:211], a[180:183], v[28:31]
    buffer_load_dwordx4 a[148:151], v5, s[16:19], s32 offen
    v_mfma_f32_16x16x32_bf16 v[48:51], a[208:211], a[184:187], v[48:51]
    v_mfma_f32_16x16x32_bf16 v[68:71], a[208:211], a[188:191], v[68:71]
    buffer_load_dwordx4 a[152:155], v6, s[16:19], s32 offen
    v_mfma_f32_16x16x32_bf16 v[88:91], a[208:211], a[192:195], v[88:91]
    v_mfma_f32_16x16x32_bf16 v[32:35], a[212:215], a[180:183], v[32:35]
    buffer_load_dwordx4 a[156:159], v7, s[16:19], s32 offen
    s_add_u32 s32, s32, 4096
    v_mfma_f32_16x16x32_bf16 v[52:55], a[212:215], a[184:187], v[52:55]
    v_mfma_f32_16x16x32_bf16 v[72:75], a[212:215], a[188:191], v[72:75]
    v_mfma_f32_16x16x32_bf16 v[92:95], a[212:215], a[192:195], v[92:95]
    s_waitcnt vmcnt(36)
    v_mfma_f32_16x16x32_bf16 v[16:19], a[16:19], a[0:3], v[16:19]
    buffer_load_dwordx4 a[196:199], v8, s[20:23], s32 offen
    v_mfma_f32_16x16x32_bf16 v[36:39], a[16:19], a[4:7], v[36:39]
    v_mfma_f32_16x16x32_bf16 v[56:59], a[16:19], a[8:11], v[56:59]
    buffer_load_dwordx4 a[200:203], v9, s[20:23], s32 offen
    v_mfma_f32_16x16x32_bf16 v[76:79], a[16:19], a[12:15], v[76:79]
    v_mfma_f32_16x16x32_bf16 v[20:23], a[20:23], a[0:3], v[20:23]
    buffer_load_dwordx4 a[204:207], v10, s[20:23], s32 offen
    v_mfma_f32_16x16x32_bf16 v[40:43], a[20:23], a[4:7], v[40:43]
    v_mfma_f32_16x16x32_bf16 v[60:63], a[20:23], a[8:11], v[60:63]
    buffer_load_dwordx4 a[208:211], v11, s[20:23], s32 offen
    v_mfma_f32_16x16x32_bf16 v[80:83], a[20:23], a[12:15], v[80:83]
    v_mfma_f32_16x16x32_bf16 v[24:27], a[24:27], a[0:3], v[24:27]
    buffer_load_dwordx4 a[212:215], v12, s[20:23], s32 offen
    v_mfma_f32_16x16x32_bf16 v[44:47], a[24:27], a[4:7], v[44:47]
    v_mfma_f32_16x16x32_bf16 v[64:67], a[24:27], a[8:11], v[64:67]
    buffer_load_dwordx4 a[180:183], v4, s[16:19], s32 offen
    v_mfma_f32_16x16x32_bf16 v[84:87], a[24:27], a[12:15], v[84:87]
    v_mfma_f32_16x16x32_bf16 v[28:31], a[28:31], a[0:3], v[28:31]
    buffer_load_dwordx4 a[184:187], v5, s[16:19], s32 offen
    v_mfma_f32_16x16x32_bf16 v[48:51], a[28:31], a[4:7], v[48:51]
    v_mfma_f32_16x16x32_bf16 v[68:71], a[28:31], a[8:11], v[68:71]
    buffer_load_dwordx4 a[188:191], v6, s[16:19], s32 offen
    v_mfma_f32_16x16x32_bf16 v[88:91], a[28:31], a[12:15], v[88:91]
    v_mfma_f32_16x16x32_bf16 v[32:35], a[32:35], a[0:3], v[32:35]
    buffer_load_dwordx4 a[192:195], v7, s[16:19], s32 offen
    s_add_u32 s32, s32, 4096
    v_mfma_f32_16x16x32_bf16 v[52:55], a[32:35], a[4:7], v[52:55]
    v_mfma_f32_16x16x32_bf16 v[72:75], a[32:35], a[8:11], v[72:75]
    v_mfma_f32_16x16x32_bf16 v[92:95], a[32:35], a[12:15], v[92:95]
    s_waitcnt vmcnt(36)
    v_mfma_f32_16x16x32_bf16 v[16:19], a[52:55], a[36:39], v[16:19]
    s_cmp_eq_u32 s3, 3
    s_cselect_b32 s33, 1073741824, s32
    buffer_load_dwordx4 a[16:19], v8, s[20:23], s33 offen
    v_mfma_f32_16x16x32_bf16 v[36:39], a[52:55], a[40:43], v[36:39]
    v_mfma_f32_16x16x32_bf16 v[56:59], a[52:55], a[44:47], v[56:59]
    buffer_load_dwordx4 a[20:23], v9, s[20:23], s33 offen
    v_mfma_f32_16x16x32_bf16 v[76:79], a[52:55], a[48:51], v[76:79]
    v_mfma_f32_16x16x32_bf16 v[20:23], a[56:59], a[36:39], v[20:23]
    buffer_load_dwordx4 a[24:27], v10, s[20:23], s33 offen
    v_mfma_f32_16x16x32_bf16 v[40:43], a[56:59], a[40:43], v[40:43]
    v_mfma_f32_16x16x32_bf16 v[60:63], a[56:59], a[44:47], v[60:63]
    buffer_load_dwordx4 a[28:31], v11, s[20:23], s33 offen
    v_mfma_f32_16x16x32_bf16 v[80:83], a[56:59], a[48:51], v[80:83]
    v_mfma_f32_16x16x32_bf16 v[24:27], a[60:63], a[36:39], v[24:27]
    buffer_load_dwordx4 a[32:35], v12, s[20:23], s33 offen
    v_mfma_f32_16x16x32_bf16 v[44:47], a[60:63], a[40:43], v[44:47]
    v_mfma_f32_16x16x32_bf16 v[64:67], a[60:63], a[44:47], v[64:67]
    buffer_load_dwordx4 a[0:3], v4, s[16:19], s32 offen
    v_mfma_f32_16x16x32_bf16 v[84:87], a[60:63], a[48:51], v[84:87]
    v_mfma_f32_16x16x32_bf16 v[28:31], a[64:67], a[36:39], v[28:31]
    buffer_load_dwordx4 a[4:7], v5, s[16:19], s32 offen
    v_mfma_f32_16x16x32_bf16 v[48:51], a[64:67], a[40:43], v[48:51]
    v_mfma_f32_16x16x32_bf16 v[68:71], a[64:67], a[44:47], v[68:71]
    buffer_load_dwordx4 a[8:11], v6, s[16:19], s32 offen
    v_mfma_f32_16x16x32_bf16 v[88:91], a[64:67], a[48:51], v[88:91]
    v_mfma_f32_16x16x32_bf16 v[32:35], a[68:71], a[36:39], v[32:35]
    buffer_load_dwordx4 a[12:15], v7, s[16:19], s32 offen
    s_add_u32 s32, s32, 4096
    v_mfma_f32_16x16x32_bf16 v[52:55], a[68:71], a[40:43], v[52:55]
    v_mfma_f32_16x16x32_bf16 v[72:75], a[68:71], a[44:47], v[72:75]
    v_mfma_f32_16x16x32_bf16 v[92:95], a[68:71], a[48:51], v[92:95]
    s_waitcnt vmcnt(36)
    v_mfma_f32_16x16x32_bf16 v[16:19], a[88:91], a[72:75], v[16:19]
    buffer_load_dwordx2 v[96:97], v13, s[24:27], 0 offen offset:0
    v_mfma_f32_16x16x32_bf16 v[36:39], a[88:91], a[76:79], v[36:39]
    v_mfma_f32_16x16x32_bf16 v[56:59], a[88:91], a[80:83], v[56:59]
    buffer_load_dwordx2 v[98:99], v13, s[24:27], 0 offen offset:256
    v_mfma_f32_16x16x32_bf16 v[76:79], a[88:91], a[84:87], v[76:79]
    v_mfma_f32_16x16x32_bf16 v[20:23], a[92:95], a[72:75], v[20:23]
    buffer_load_dwordx2 v[100:101], v13, s[24:27], 0 offen offset:512
    v_mfma_f32_16x16x32_bf16 v[40:43], a[92:95], a[76:79], v[40:43]
    v_mfma_f32_16x16x32_bf16 v[60:63], a[92:95], a[80:83], v[60:63]
    buffer_load_dwordx2 v[102:103], v13, s[24:27], 0 offen offset:768
    v_mfma_f32_16x16x32_bf16 v[80:83], a[92:95], a[84:87], v[80:83]
    v_mfma_f32_16x16x32_bf16 v[24:27], a[96:99], a[72:75], v[24:27]
    buffer_load_dwordx2 v[104:105], v13, s[24:27], 0 offen offset:1024
    v_mfma_f32_16x16x32_bf16 v[44:47], a[96:99], a[76:79], v[44:47]
    v_mfma_f32_16x16x32_bf16 v[64:67], a[96:99], a[80:83], v[64:67]
    buffer_load_dwordx2 v[108:109], v14, s[28:31], 0 offen offset:0
    v_mfma_f32_16x16x32_bf16 v[84:87], a[96:99], a[84:87], v[84:87]
    v_mfma_f32_16x16x32_bf16 v[28:31], a[100:103], a[72:75], v[28:31]
    buffer_load_dwordx2 v[110:111], v14, s[28:31], 0 offen offset:256
    v_mfma_f32_16x16x32_bf16 v[48:51], a[100:103], a[76:79], v[48:51]
    v_mfma_f32_16x16x32_bf16 v[68:71], a[100:103], a[80:83], v[68:71]
    buffer_load_dwordx2 v[112:113], v14, s[28:31], 0 offen offset:512
    v_mfma_f32_16x16x32_bf16 v[88:91], a[100:103], a[84:87], v[88:91]
    v_mfma_f32_16x16x32_bf16 v[32:35], a[104:107], a[72:75], v[32:35]
    buffer_load_dwordx2 v[114:115], v14, s[28:31], 0 offen offset:768
    v_mfma_f32_16x16x32_bf16 v[52:55], a[104:107], a[76:79], v[52:55]
    v_mfma_f32_16x16x32_bf16 v[72:75], a[104:107], a[80:83], v[72:75]
    buffer_load_dwordx2 v[116:117], v14, s[28:31], 0 offen offset:1024
    v_mfma_f32_16x16x32_bf16 v[92:95], a[104:107], a[84:87], v[92:95]
    s_waitcnt vmcnt(37)
    v_mfma_f32_16x16x32_bf16 v[16:19], a[124:127], a[108:111], v[16:19]
    v_mfma_f32_16x16x32_bf16 v[36:39], a[124:127], a[112:115], v[36:39]
    v_mfma_f32_16x16x32_bf16 v[56:59], a[124:127], a[116:119], v[56:59]
    v_mfma_f32_16x16x32_bf16 v[76:79], a[124:127], a[120:123], v[76:79]
    v_mfma_f32_16x16x32_bf16 v[20:23], a[128:131], a[108:111], v[20:23]
    v_mfma_f32_16x16x32_bf16 v[40:43], a[128:131], a[112:115], v[40:43]
    v_mfma_f32_16x16x32_bf16 v[60:63], a[128:131], a[116:119], v[60:63]
    v_mfma_f32_16x16x32_bf16 v[80:83], a[128:131], a[120:123], v[80:83]
    v_mfma_f32_16x16x32_bf16 v[24:27], a[132:135], a[108:111], v[24:27]
    v_mfma_f32_16x16x32_bf16 v[44:47], a[132:135], a[112:115], v[44:47]
    v_mfma_f32_16x16x32_bf16 v[64:67], a[132:135], a[116:119], v[64:67]
    v_mfma_f32_16x16x32_bf16 v[84:87], a[132:135], a[120:123], v[84:87]
    v_mfma_f32_16x16x32_bf16 v[28:31], a[136:139], a[108:111], v[28:31]
    v_mfma_f32_16x16x32_bf16 v[48:51], a[136:139], a[112:115], v[48:51]
    v_mfma_f32_16x16x32_bf16 v[68:71], a[136:139], a[116:119], v[68:71]
    v_mfma_f32_16x16x32_bf16 v[88:91], a[136:139], a[120:123], v[88:91]
    v_mfma_f32_16x16x32_bf16 v[32:35], a[140:143], a[108:111], v[32:35]
    v_mfma_f32_16x16x32_bf16 v[52:55], a[140:143], a[112:115], v[52:55]
    v_mfma_f32_16x16x32_bf16 v[72:75], a[140:143], a[116:119], v[72:75]
    v_mfma_f32_16x16x32_bf16 v[92:95], a[140:143], a[120:123], v[92:95]
    s_waitcnt vmcnt(28)
    v_mfma_f32_16x16x32_bf16 v[16:19], a[160:163], a[144:147], v[16:19]
    v_mfma_f32_16x16x32_bf16 v[36:39], a[160:163], a[148:151], v[36:39]
    v_mfma_f32_16x16x32_bf16 v[56:59], a[160:163], a[152:155], v[56:59]
    v_mfma_f32_16x16x32_bf16 v[76:79], a[160:163], a[156:159], v[76:79]
    v_mfma_f32_16x16x32_bf16 v[20:23], a[164:167], a[144:147], v[20:23]
    v_mfma_f32_16x16x32_bf16 v[40:43], a[164:167], a[148:151], v[40:43]
    v_mfma_f32_16x16x32_bf16 v[60:63], a[164:167], a[152:155], v[60:63]
    v_mfma_f32_16x16x32_bf16 v[80:83], a[164:167], a[156:159], v[80:83]
    v_mfma_f32_16x16x32_bf16 v[24:27], a[168:171], a[144:147], v[24:27]
    v_mfma_f32_16x16x32_bf16 v[44:47], a[168:171], a[148:151], v[44:47]
    v_mfma_f32_16x16x32_bf16 v[64:67], a[168:171], a[152:155], v[64:67]
    v_mfma_f32_16x16x32_bf16 v[84:87], a[168:171], a[156:159], v[84:87]
    v_mfma_f32_16x16x32_bf16 v[28:31], a[172:175], a[144:147], v[28:31]
    v_mfma_f32_16x16x32_bf16 v[48:51], a[172:175], a[148:151], v[48:51]
    v_mfma_f32_16x16x32_bf16 v[68:71], a[172:175], a[152:155], v[68:71]
    v_mfma_f32_16x16x32_bf16 v[88:91], a[172:175], a[156:159], v[88:91]
    v_mfma_f32_16x16x32_bf16 v[32:35], a[176:179], a[144:147], v[32:35]
    v_mfma_f32_16x16x32_bf16 v[52:55], a[176:179], a[148:151], v[52:55]
    v_mfma_f32_16x16x32_bf16 v[72:75], a[176:179], a[152:155], v[72:75]
    v_mfma_f32_16x16x32_bf16 v[92:95], a[176:179], a[156:159], v[92:95]
    s_waitcnt vmcnt(19)
    v_mfma_f32_16x16x32_bf16 v[16:19], a[196:199], a[180:183], v[16:19]
    v_mfma_f32_16x16x32_bf16 v[36:39], a[196:199], a[184:187], v[36:39]
    v_mfma_f32_16x16x32_bf16 v[56:59], a[196:199], a[188:191], v[56:59]
    v_mfma_f32_16x16x32_bf16 v[76:79], a[196:199], a[192:195], v[76:79]
    v_mfma_f32_16x16x32_bf16 v[20:23], a[200:203], a[180:183], v[20:23]
    v_mfma_f32_16x16x32_bf16 v[40:43], a[200:203], a[184:187], v[40:43]
    v_mfma_f32_16x16x32_bf16 v[60:63], a[200:203], a[188:191], v[60:63]
    v_mfma_f32_16x16x32_bf16 v[80:83], a[200:203], a[192:195], v[80:83]
    v_mfma_f32_16x16x32_bf16 v[24:27], a[204:207], a[180:183], v[24:27]
    v_mfma_f32_16x16x32_bf16 v[44:47], a[204:207], a[184:187], v[44:47]
    v_mfma_f32_16x16x32_bf16 v[64:67], a[204:207], a[188:191], v[64:67]
    v_mfma_f32_16x16x32_bf16 v[84:87], a[204:207], a[192:195], v[84:87]
    v_mfma_f32_16x16x32_bf16 v[28:31], a[208:211], a[180:183], v[28:31]
    v_mfma_f32_16x16x32_bf16 v[48:51], a[208:211], a[184:187], v[48:51]
    v_mfma_f32_16x16x32_bf16 v[68:71], a[208:211], a[188:191], v[68:71]
    v_mfma_f32_16x16x32_bf16 v[88:91], a[208:211], a[192:195], v[88:91]
    v_mfma_f32_16x16x32_bf16 v[32:35], a[212:215], a[180:183], v[32:35]
    v_mfma_f32_16x16x32_bf16 v[52:55], a[212:215], a[184:187], v[52:55]
    v_mfma_f32_16x16x32_bf16 v[72:75], a[212:215], a[188:191], v[72:75]
    v_mfma_f32_16x16x32_bf16 v[92:95], a[212:215], a[192:195], v[92:95]
    s_waitcnt vmcnt(10)
    v_mfma_f32_16x16x32_bf16 v[16:19], a[16:19], a[0:3], v[16:19]
    v_mfma_f32_16x16x32_bf16 v[36:39], a[16:19], a[4:7], v[36:39]
    v_mfma_f32_16x16x32_bf16 v[56:59], a[16:19], a[8:11], v[56:59]
    v_mfma_f32_16x16x32_bf16 v[76:79], a[16:19], a[12:15], v[76:79]
    v_mfma_f32_16x16x32_bf16 v[20:23], a[20:23], a[0:3], v[20:23]
    v_mfma_f32_16x16x32_bf16 v[40:43], a[20:23], a[4:7], v[40:43]
    v_mfma_f32_16x16x32_bf16 v[60:63], a[20:23], a[8:11], v[60:63]
    v_mfma_f32_16x16x32_bf16 v[80:83], a[20:23], a[12:15], v[80:83]
    v_mfma_f32_16x16x32_bf16 v[24:27], a[24:27], a[0:3], v[24:27]
    v_mfma_f32_16x16x32_bf16 v[44:47], a[24:27], a[4:7], v[44:47]
    v_mfma_f32_16x16x32_bf16 v[64:67], a[24:27], a[8:11], v[64:67]
    v_mfma_f32_16x16x32_bf16 v[84:87], a[24:27], a[12:15], v[84:87]
    v_mfma_f32_16x16x32_bf16 v[28:31], a[28:31], a[0:3], v[28:31]
    v_mfma_f32_16x16x32_bf16 v[48:51], a[28:31], a[4:7], v[48:51]
    v_mfma_f32_16x16x32_bf16 v[68:71], a[28:31], a[8:11], v[68:71]
    v_mfma_f32_16x16x32_bf16 v[88:91], a[28:31], a[12:15], v[88:91]
    v_mfma_f32_16x16x32_bf16 v[32:35], a[32:35], a[0:3], v[32:35]
    v_mfma_f32_16x16x32_bf16 v[52:55], a[32:35], a[4:7], v[52:55]
    v_mfma_f32_16x16x32_bf16 v[72:75], a[32:35], a[8:11], v[72:75]
    v_mfma_f32_16x16x32_bf16 v[92:95], a[32:35], a[12:15], v[92:95]
    s_add_u32 s12, s3, 1
    s_and_b32 s12, s12, 3
    s_mul_i32 s12, s12, 15360
    s_add_u32 s12, s12, 0
    v_add_u32 v5, s12, v3
    s_add_u32 s12, s3, 2
    s_and_b32 s12, s12, 3
    s_mul_i32 s12, s12, 15360
    s_add_u32 s12, s12, 5120
    v_add_u32 v6, s12, v3
    s_add_u32 s12, s3, 3
    s_and_b32 s12, s12, 3
    s_mul_i32 s12, s12, 15360
    s_add_u32 s12, s12, 10240
    v_add_u32 v7, s12, v3
    s_mul_i32 s12, s3, 15360
    v_add_u32 v4, s12, v3
    ds_write_b128 v5, v[36:39] offset:0
    ds_write_b128 v5, v[40:43] offset:1024
    ds_write_b128 v5, v[44:47] offset:2048
    ds_write_b128 v5, v[48:51] offset:3072
    ds_write_b128 v5, v[52:55] offset:4096
    ds_write_b128 v6, v[56:59] offset:0
    ds_write_b128 v6, v[60:63] offset:1024
    ds_write_b128 v6, v[64:67] offset:2048
    ds_write_b128 v6, v[68:71] offset:3072
    ds_write_b128 v6, v[72:75] offset:4096
    ds_write_b128 v7, v[76:79] offset:0
    ds_write_b128 v7, v[80:83] offset:1024
    ds_write_b128 v7, v[84:87] offset:2048
    ds_write_b128 v7, v[88:91] offset:3072
    ds_write_b128 v7, v[92:95] offset:4096
    s_waitcnt vmcnt(0)
    v_lshlrev_b32 v120, 16, v96
    v_and_b32 v121, 0xffff0000, v96
    v_lshlrev_b32 v140, 16, v108
    v_and_b32 v141, 0xffff0000, v108
    v_pk_add_f32 v[16:17], v[16:17], v[120:121]
    v_pk_add_f32 v[16:17], v[16:17], v[140:141]
    v_lshlrev_b32 v122, 16, v97
    v_and_b32 v123, 0xffff0000, v97
    v_lshlrev_b32 v142, 16, v109
    v_and_b32 v143, 0xffff0000, v109
    v_pk_add_f32 v[18:19], v[18:19], v[122:123]
    v_pk_add_f32 v[18:19], v[18:19], v[142:143]
    v_lshlrev_b32 v124, 16, v98
    v_and_b32 v125, 0xffff0000, v98
    v_lshlrev_b32 v144, 16, v110
    v_and_b32 v145, 0xffff0000, v110
    v_pk_add_f32 v[20:21], v[20:21], v[124:125]
    v_pk_add_f32 v[20:21], v[20:21], v[144:145]
    v_lshlrev_b32 v126, 16, v99
    v_and_b32 v127, 0xffff0000, v99
    v_lshlrev_b32 v146, 16, v111
    v_and_b32 v147, 0xffff0000, v111
    v_pk_add_f32 v[22:23], v[22:23], v[126:127]
    v_pk_add_f32 v[22:23], v[22:23], v[146:147]
    v_lshlrev_b32 v128, 16, v100
    v_and_b32 v129, 0xffff0000, v100
    v_lshlrev_b32 v148, 16, v112
    v_and_b32 v149, 0xffff0000, v112
    v_pk_add_f32 v[24:25], v[24:25], v[128:129]
    v_pk_add_f32 v[24:25], v[24:25], v[148:149]
    v_lshlrev_b32 v130, 16, v101
    v_and_b32 v131, 0xffff0000, v101
    v_lshlrev_b32 v150, 16, v113
    v_and_b32 v151, 0xffff0000, v113
    v_pk_add_f32 v[26:27], v[26:27], v[130:131]
    v_pk_add_f32 v[26:27], v[26:27], v[150:151]
    v_lshlrev_b32 v132, 16, v102
    v_and_b32 v133, 0xffff0000, v102
    v_lshlrev_b32 v152, 16, v114
    v_and_b32 v153, 0xffff0000, v114
    v_pk_add_f32 v[28:29], v[28:29], v[132:133]
    v_pk_add_f32 v[28:29], v[28:29], v[152:153]
    v_lshlrev_b32 v134, 16, v103
    v_and_b32 v135, 0xffff0000, v103
    v_lshlrev_b32 v154, 16, v115
    v_and_b32 v155, 0xffff0000, v115
    v_pk_add_f32 v[30:31], v[30:31], v[134:135]
    v_pk_add_f32 v[30:31], v[30:31], v[154:155]
    v_lshlrev_b32 v136, 16, v104
    v_and_b32 v137, 0xffff0000, v104
    v_lshlrev_b32 v156, 16, v116
    v_and_b32 v157, 0xffff0000, v116
    v_pk_add_f32 v[32:33], v[32:33], v[136:137]
    v_pk_add_f32 v[32:33], v[32:33], v[156:157]
    v_lshlrev_b32 v138, 16, v105
    v_and_b32 v139, 0xffff0000, v105
    v_lshlrev_b32 v158, 16, v117
    v_and_b32 v159, 0xffff0000, v117
    v_pk_add_f32 v[34:35], v[34:35], v[138:139]
    v_pk_add_f32 v[34:35], v[34:35], v[158:159]
    s_waitcnt lgkmcnt(0)
    s_barrier
    ds_read_b128 v[120:123], v4 offset:0
    ds_read_b128 v[124:127], v4 offset:1024
    ds_read_b128 v[128:131], v4 offset:2048
    ds_read_b128 v[132:135], v4 offset:3072
    ds_read_b128 v[136:139], v4 offset:4096
    ds_read_b128 v[140:143], v4 offset:5120
    ds_read_b128 v[144:147], v4 offset:6144
    ds_read_b128 v[148:151], v4 offset:7168
    ds_read_b128 v[152:155], v4 offset:8192
    ds_read_b128 v[156:159], v4 offset:9216
    ds_read_b128 v[160:163], v4 offset:10240
    ds_read_b128 v[164:167], v4 offset:11264
    ds_read_b128 v[168:171], v4 offset:12288
    ds_read_b128 v[172:175], v4 offset:13312
    ds_read_b128 v[176:179], v4 offset:14336
    s_waitcnt lgkmcnt(10)
    v_pk_add_f32 v[16:17], v[16:17], v[120:121]
    v_pk_add_f32 v[18:19], v[18:19], v[122:123]
    v_pk_add_f32 v[20:21], v[20:21], v[124:125]
    v_pk_add_f32 v[22:23], v[22:23], v[126:127]
    v_pk_add_f32 v[24:25], v[24:25], v[128:129]
    v_pk_add_f32 v[26:27], v[26:27], v[130:131]
    v_pk_add_f32 v[28:29], v[28:29], v[132:133]
    v_pk_add_f32 v[30:31], v[30:31], v[134:135]
    v_pk_add_f32 v[32:33], v[32:33], v[136:137]
    v_pk_add_f32 v[34:35], v[34:35], v[138:139]
    s_waitcnt lgkmcnt(5)
    v_pk_add_f32 v[16:17], v[16:17], v[140:141]
    v_pk_add_f32 v[18:19], v[18:19], v[142:143]
    v_pk_add_f32 v[20:21], v[20:21], v[144:145]
    v_pk_add_f32 v[22:23], v[22:23], v[146:147]
    v_pk_add_f32 v[24:25], v[24:25], v[148:149]
    v_pk_add_f32 v[26:27], v[26:27], v[150:151]
    v_pk_add_f32 v[28:29], v[28:29], v[152:153]
    v_pk_add_f32 v[30:31], v[30:31], v[154:155]
    v_pk_add_f32 v[32:33], v[32:33], v[156:157]
    v_pk_add_f32 v[34:35], v[34:35], v[158:159]
    s_waitcnt lgkmcnt(0)
    v_pk_add_f32 v[16:17], v[16:17], v[160:161]
    v_pk_add_f32 v[18:19], v[18:19], v[162:163]
    v_pk_add_f32 v[20:21], v[20:21], v[164:165]
    v_pk_add_f32 v[22:23], v[22:23], v[166:167]
    v_pk_add_f32 v[24:25], v[24:25], v[168:169]
    v_pk_add_f32 v[26:27], v[26:27], v[170:171]
    v_pk_add_f32 v[28:29], v[28:29], v[172:173]
    v_pk_add_f32 v[30:31], v[30:31], v[174:175]
    v_pk_add_f32 v[32:33], v[32:33], v[176:177]
    v_pk_add_f32 v[34:35], v[34:35], v[178:179]
    v_cvt_pk_bf16_f32 v96, v16, v17
    v_cvt_pk_bf16_f32 v97, v18, v19
    v_cvt_pk_bf16_f32 v98, v20, v21
    v_cvt_pk_bf16_f32 v99, v22, v23
    v_cvt_pk_bf16_f32 v100, v24, v25
    v_cvt_pk_bf16_f32 v101, v26, v27
    v_cvt_pk_bf16_f32 v102, v28, v29
    v_cvt_pk_bf16_f32 v103, v30, v31
    v_cvt_pk_bf16_f32 v104, v32, v33
    v_cvt_pk_bf16_f32 v105, v34, v35
    buffer_store_dwordx2 v[96:97], v13, s[36:39], 0 offen offset:0
    buffer_store_dwordx2 v[98:99], v13, s[36:39], 0 offen offset:256
    buffer_store_dwordx2 v[100:101], v13, s[36:39], 0 offen offset:512
    buffer_store_dwordx2 v[102:103], v13, s[36:39], 0 offen offset:768
    buffer_store_dwordx2 v[104:105], v13, s[36:39], 0 offen offset:1024
    s_endpgm
K3_END:
    s_endpgm
.section .rodata,"a"
.p2align 6
.amdhsa_kernel k1_kernel
  .amdhsa_next_free_vgpr 256
  .amdhsa_next_free_sgpr 96
  .amdhsa_accum_offset 256
  .amdhsa_group_segment_fixed_size 0
  .amdhsa_kernarg_size 88
  .amdhsa_user_sgpr_count 2
  .amdhsa_user_sgpr_kernarg_segment_ptr 1
  .amdhsa_system_sgpr_workgroup_id_x 1
.end_amdhsa_kernel
.p2align 6
.amdhsa_kernel k2_kernel
  .amdhsa_next_free_vgpr 376
  .amdhsa_next_free_sgpr 96
  .amdhsa_accum_offset 256
  .amdhsa_group_segment_fixed_size 0
  .amdhsa_kernarg_size 88
  .amdhsa_user_sgpr_count 2
  .amdhsa_user_sgpr_kernarg_segment_ptr 1
  .amdhsa_system_sgpr_workgroup_id_x 1
.end_amdhsa_kernel
.p2align 6
.amdhsa_kernel k3_kernel
  .amdhsa_next_free_vgpr 472
  .amdhsa_next_free_sgpr 96
  .amdhsa_accum_offset 256
  .amdhsa_group_segment_fixed_size 0
  .amdhsa_kernarg_size 88
  .amdhsa_user_sgpr_count 2
  .amdhsa_user_sgpr_kernarg_segment_ptr 1
  .amdhsa_system_sgpr_workgroup_id_x 1
.end_amdhsa_kernel
```
